```python
import torch

def _softmax(x, axis=-1):
    return torch.softmax(x, dim=axis)

def _gelu(x):
    return torch.nn.functional.gelu(x, approximate='tanh')

def _silu(x):
    return torch.nn.functional.silu(x)

def _sigmoid(x):
    return torch.sigmoid(x)

def _layernorm(x, axis=-1, eps=1e-05):
    m = x.mean(dim=axis, keepdim=True)
    v = x.var(dim=axis, keepdim=True, unbiased=False)
    return (x - m) / torch.sqrt(v + eps)

def _scatter_add(tgt, idx, src, axis=0):
    return tgt.clone().index_add_(axis, idx, src)

def _segment_sum(src, seg, n):
    out = torch.zeros((n,) + src.shape[1:], dtype=src.dtype)
    return out.index_add_(0, seg, src)

def _pad(x, pw):
    flat = tuple((v for pair in reversed(pw) for v in pair))
    return torch.nn.functional.pad(x, flat)
kernel_name = 'standalone__mixer_gmlp__prompt'

def setup_inputs():

    _w = lambda a: (lambda t: t.to(torch.bfloat16) if t.is_floating_point() else t)(torch.as_tensor(a))
    B, S, D, F = (1, 2048, 576, 4608)
    Fh = F // 2
    return {'x': _w((lambda *s: torch.randn(*s, dtype=torch.bfloat16) * 0.05)(B, S, D)), 'w_in': _w((lambda *s: torch.randn(*s, dtype=torch.bfloat16) * 0.4)(D, 2 * Fh)), 'w_sp': _w(0.01 * (lambda *s: torch.randn(*s, dtype=torch.bfloat16) * 0.4)(S, S)), 'b_sp': _w(1.0 + 0.01 * (lambda *s: torch.randn(*s, dtype=torch.bfloat16) * 0.05)(S)), 'w_out': _w((lambda *s: torch.randn(*s, dtype=torch.bfloat16) * 0.05)(Fh, D))}

def reference(x, w_in, w_sp, b_sp, w_out):
    B, S, D = x.shape
    F = w_in.shape[-1]
    Fh = F // 2
    z = _gelu(torch.einsum('bsd,df->bsf', x, w_in))
    z1 = z[..., :Fh].clone()
    z2 = _layernorm(z[..., Fh:], axis=-1)
    g = torch.einsum('ts,bsf->btf', w_sp, z2) + b_sp[None, :, None]
    return torch.einsum('bsf,fd->bsd', z1 * g, w_out)
```

```asm
; @launch grid=(256,1,1) block=(512,1,1) lds=160768
.amdgcn_target "amdgcn-amd-amdhsa--gfx950"
.text
.globl standalone__mixer_gmlp__prompt_kernel
.p2align 8
.type standalone__mixer_gmlp__prompt_kernel,@function
standalone__mixer_gmlp__prompt_kernel:
    s_cmp_ge_u32 s2, 256
    s_cbranch_scc1 L_end
    s_load_dwordx16 s[4:19], s[0:1], 0
    v_lshrrev_b32 v1, 6, v0
    v_and_b32 v0, 63, v0
    v_readfirstlane_b32 s52, v1
    s_and_b32 s55, s2, 7
    s_lshr_b32 s57, s2, 3
    s_and_b32 s53, s55, 1
    s_lshl_b32 s53, s53, 3
    s_and_b32 s58, s57, 7
    s_add_u32 s53, s53, s58
    s_lshr_b32 s54, s55, 1
    s_lshl_b32 s54, s54, 2
    s_lshr_b32 s58, s57, 3
    s_add_u32 s54, s54, s58
    s_lshr_b32 s84, s54, 3
    s_lshl_b32 s58, s53, 1
    s_add_u32 s84, s84, s58
    s_and_b32 s85, s54, 7
    s_cmp_ge_u32 s52, 4
    s_cbranch_scc1 L_consumer
    s_setprio 3
    v_lshrrev_b32 v232, 5, v0
    v_lshlrev_b32 v232, 3, v232
    v_bfe_u32 v233, v0, 3, 2
    v_add_u32 v232, v232, v233
    v_and_b32 v233, 7, v0
    v_bfe_u32 v234, v0, 4, 2
    v_xor_b32 v233, v233, v234
    v_lshlrev_b32 v233, 4, v233
    v_xor_b32 v234, 64, v233
    s_lshl_b32 s57, s53, 7
    s_lshl_b32 s58, s52, 5
    s_add_u32 s57, s57, s58
    v_add_u32 v232, s57, v232
    v_mul_u32_u24 v235, 1152, v232
    v_add_u32 v236, v235, v234
    v_add_u32 v235, v235, v233
    v_add_u32 v2, 0, v235
    v_add_u32 v3, 17408, v236
    v_add_u32 v4, 2560, v235
    v_add_u32 v5, 19968, v236
    s_lshl_b32 s71, s52, 12
    s_add_u32 s72, s71, 139264
    s_mul_i32 s73, s52, 4608
    s_add_u32 s73, s73, 16384
    s_add_u32 s74, s73, 139264
    s_and_b32 s75, s55, 6
    s_and_b32 s58, s55, 1
    s_mul_i32 s58, s58, 5
    s_add_u32 s75, s75, s58
    s_sub_u32 s58, s75, 9
    s_cmp_ge_u32 s75, 9
    s_cselect_b32 s75, s58, s75
    s_mov_b32 s63, 0
    s_add_u32 s64, s63, 1152
    s_mul_i32 s62, s75, 128
    s_add_u32 s62, s62, s63
    s_waitcnt lgkmcnt(0)
    s_mov_b32 s20, s4
    s_mov_b32 s21, s5
    s_mov_b32 s22, 2359296
    s_mov_b32 s23, 0x20000
    s_add_u32 m0, s71, 0
    s_nop 0
    buffer_load_dwordx4 v2, s[20:23], s62 offen offset:0 lds
    buffer_load_dwordx4 v3, s[20:23], s62 offen offset:1024 lds
    buffer_load_dwordx4 v4, s[20:23], s62 offen offset:2048 lds
    buffer_load_dwordx4 v5, s[20:23], s62 offen offset:3072 lds
    s_add_u32 s62, s62, 128
    s_cmp_eq_u32 s62, s64
    s_cselect_b32 s62, s63, s62
    s_mul_i32 s57, s52, 147456
    s_mul_i32 s58, s54, 288
    s_add_u32 s57, s57, s58
    s_add_u32 s67, s57, 4608
    s_add_u32 s68, s67, 5308416
    s_mul_i32 s66, s75, 589824
    s_add_u32 s66, s66, s67
    s_mov_b32 s24, s6
    s_mov_b32 s25, s7
    s_mov_b32 s26, 5308416
    s_mov_b32 s27, 0x20000
    v_add_u32 v236, 0, v0
    v_mul_u32_u24 v237, 3641, v236
    v_lshrrev_b32 v237, 16, v237
    v_mul_u32_u24 v238, 18, v237
    v_sub_u32 v236, v236, v238
    v_and_b32 v238, 3, v237
    v_bfe_u32 v239, v237, 2, 1
    v_lshl_or_b32 v238, v239, 3, v238
    v_bfe_u32 v239, v237, 3, 1
    v_lshl_or_b32 v238, v239, 2, v238
    v_mul_u32_u24 v238, 9216, v238
    v_lshl_add_u32 v6, v236, 4, v238
    v_add_u32 v236, 64, v0
    v_mul_u32_u24 v237, 3641, v236
    v_lshrrev_b32 v237, 16, v237
    v_mul_u32_u24 v238, 18, v237
    v_sub_u32 v236, v236, v238
    v_and_b32 v238, 3, v237
    v_bfe_u32 v239, v237, 2, 1
    v_lshl_or_b32 v238, v239, 3, v238
    v_bfe_u32 v239, v237, 3, 1
    v_lshl_or_b32 v238, v239, 2, v238
    v_mul_u32_u24 v238, 9216, v238
    v_lshl_add_u32 v7, v236, 4, v238
    v_subrev_u32 v7, 1024, v7
    v_add_u32 v236, 128, v0
    v_mul_u32_u24 v237, 3641, v236
    v_lshrrev_b32 v237, 16, v237
    v_mul_u32_u24 v238, 18, v237
    v_sub_u32 v236, v236, v238
    v_and_b32 v238, 3, v237
    v_bfe_u32 v239, v237, 2, 1
    v_lshl_or_b32 v238, v239, 3, v238
    v_bfe_u32 v239, v237, 3, 1
    v_lshl_or_b32 v238, v239, 2, v238
    v_mul_u32_u24 v238, 9216, v238
    v_lshl_add_u32 v8, v236, 4, v238
    v_subrev_u32 v8, 2048, v8
    v_add_u32 v236, 192, v0
    v_mul_u32_u24 v237, 3641, v236
    v_lshrrev_b32 v237, 16, v237
    v_mul_u32_u24 v238, 18, v237
    v_sub_u32 v236, v236, v238
    v_and_b32 v238, 3, v237
    v_bfe_u32 v239, v237, 2, 1
    v_lshl_or_b32 v238, v239, 3, v238
    v_bfe_u32 v239, v237, 3, 1
    v_lshl_or_b32 v238, v239, 2, v238
    v_mul_u32_u24 v238, 9216, v238
    v_lshl_add_u32 v9, v236, 4, v238
    v_subrev_u32 v9, 3072, v9
    v_add_u32 v236, 256, v0
    v_mul_u32_u24 v237, 3641, v236
    v_lshrrev_b32 v237, 16, v237
    v_mul_u32_u24 v238, 18, v237
    v_sub_u32 v236, v236, v238
    v_and_b32 v238, 3, v237
    v_bfe_u32 v239, v237, 2, 1
    v_lshl_or_b32 v238, v239, 3, v238
    v_bfe_u32 v239, v237, 3, 1
    v_lshl_or_b32 v238, v239, 2, v238
    v_mul_u32_u24 v238, 9216, v238
    v_lshl_add_u32 v10, v236, 4, v238
    s_add_u32 m0, s73, 0
    s_nop 0
    buffer_load_dwordx4 v6, s[24:27], s66 offen offset:0 lds
    buffer_load_dwordx4 v7, s[24:27], s66 offen offset:1024 lds
    buffer_load_dwordx4 v8, s[24:27], s66 offen offset:2048 lds
    buffer_load_dwordx4 v9, s[24:27], s66 offen offset:3072 lds
    s_add_u32 m0, m0, 4096
    s_mov_b32 exec_hi, 0
    buffer_load_dwordx4 v10, s[24:27], s66 offen lds
    s_mov_b32 exec_hi, -1
    s_add_u32 s66, s66, 589824
    s_cmp_eq_u32 s66, s68
    s_cselect_b32 s66, s67, s66
    s_add_u32 m0, s71, 34816
    s_nop 0
    buffer_load_dwordx4 v2, s[20:23], s62 offen offset:0 lds
    buffer_load_dwordx4 v3, s[20:23], s62 offen offset:1024 lds
    buffer_load_dwordx4 v4, s[20:23], s62 offen offset:2048 lds
    buffer_load_dwordx4 v5, s[20:23], s62 offen offset:3072 lds
    s_add_u32 s62, s62, 128
    s_cmp_eq_u32 s62, s64
    s_cselect_b32 s62, s63, s62
    s_add_u32 m0, s73, 34816
    s_nop 0
    buffer_load_dwordx4 v6, s[24:27], s66 offen offset:0 lds
    buffer_load_dwordx4 v7, s[24:27], s66 offen offset:1024 lds
    buffer_load_dwordx4 v8, s[24:27], s66 offen offset:2048 lds
    buffer_load_dwordx4 v9, s[24:27], s66 offen offset:3072 lds
    s_add_u32 m0, m0, 4096
    s_mov_b32 exec_hi, 0
    buffer_load_dwordx4 v10, s[24:27], s66 offen lds
    s_mov_b32 exec_hi, -1
    s_add_u32 s66, s66, 589824
    s_cmp_eq_u32 s66, s68
    s_cselect_b32 s66, s67, s66
    s_mov_b32 s28, s8
    s_mov_b32 s29, s9
    s_mov_b32 s30, 8388608
    s_mov_b32 s31, 0x20000
    s_mov_b32 s32, s18
    s_mov_b32 s33, s19
    s_mov_b32 s34, 24117248
    s_mov_b32 s35, 0x20000
    s_mov_b32 s40, s16
    s_mov_b32 s41, s17
    s_mov_b32 s42, 256
    s_mov_b32 s43, 0x20000
    v_mul_u32_u24 v235, 4096, v232
    v_add_u32 v236, v235, v234
    v_add_u32 v235, v235, v233
    v_add_u32 v11, 0, v235
    v_add_u32 v12, 64512, v236
    v_add_u32 v13, 14336, v235
    v_add_u32 v14, 78848, v236
    v_lshlrev_b32 v15, 4, v0
    v_add_u32 v16, 4096, v15
    v_lshlrev_b32 v17, 2, v0
    v_and_b32 v18, 60, v17
    v_lshrrev_b32 v240, 2, v0
    v_and_b32 v17, 12, v17
    v_lshl_add_u32 v17, v240, 6, v17
    v_add_u32 v19, s71, v15
    v_add_u32 v20, 69632, v19
    v_add_u32 v21, s73, v15
    v_add_u32 v22, 69632, v21
    s_mov_b32 s44, s12
    s_mov_b32 s45, s13
    s_mov_b32 s46, 2654208
    s_mov_b32 s47, 0x20000
    s_and_b32 s90, s54, 7
    s_lshl_b32 s86, s52, 5
    s_lshr_b32 s57, s54, 3
    s_lshl_b32 s58, s53, 1
    s_add_u32 s57, s57, s58
    s_sub_u32 s57, 31, s57
    s_add_u32 s86, s86, s57
    s_mul_i32 s87, s52, 5120
    s_add_u32 s87, s87, 139264
    s_mul_i32 s88, s86, 36864
    s_mul_i32 s58, s90, 144
    s_add_u32 s88, s88, s58
    v_add_u32 v138, 0, v0
    v_mul_u32_u24 v139, 7282, v138
    v_lshrrev_b32 v139, 16, v139
    v_mul_u32_u24 v140, 9, v139
    v_sub_u32 v138, v138, v140
    v_mul_u32_u24 v139, 1152, v139
    v_lshl_add_u32 v132, v138, 4, v139
    v_add_u32 v138, 64, v0
    v_mul_u32_u24 v139, 7282, v138
    v_lshrrev_b32 v139, 16, v139
    v_mul_u32_u24 v140, 9, v139
    v_sub_u32 v138, v138, v140
    v_mul_u32_u24 v139, 1152, v139
    v_lshl_add_u32 v133, v138, 4, v139
    v_add_u32 v138, 128, v0
    v_mul_u32_u24 v139, 7282, v138
    v_lshrrev_b32 v139, 16, v139
    v_mul_u32_u24 v140, 9, v139
    v_sub_u32 v138, v138, v140
    v_mul_u32_u24 v139, 1152, v139
    v_lshl_add_u32 v134, v138, 4, v139
    v_add_u32 v138, 192, v0
    v_mul_u32_u24 v139, 7282, v138
    v_lshrrev_b32 v139, 16, v139
    v_mul_u32_u24 v140, 9, v139
    v_sub_u32 v138, v138, v140
    v_mul_u32_u24 v139, 1152, v139
    v_lshl_add_u32 v135, v138, 4, v139
    v_add_u32 v138, 256, v0
    v_min_u32 v138, 287, v138
    v_mul_u32_u24 v139, 7282, v138
    v_lshrrev_b32 v139, 16, v139
    v_mul_u32_u24 v140, 9, v139
    v_sub_u32 v138, v138, v140
    v_mul_u32_u24 v139, 1152, v139
    v_lshl_add_u32 v136, v138, 4, v139
    s_lshl_b32 s89, s53, 19
    s_lshl_b32 s58, s54, 15
    s_add_u32 s89, s89, s58
    s_lshl_b32 s58, s52, 13
    s_add_u32 s89, s89, s58
    s_waitcnt vmcnt(9) lgkmcnt(0)
    s_barrier
    s_add_u32 m0, s71, 69632
    s_nop 0
    buffer_load_dwordx4 v2, s[20:23], s62 offen offset:0 lds
    buffer_load_dwordx4 v3, s[20:23], s62 offen offset:1024 lds
    buffer_load_dwordx4 v4, s[20:23], s62 offen offset:2048 lds
    buffer_load_dwordx4 v5, s[20:23], s62 offen offset:3072 lds
    s_add_u32 s62, s62, 128
    s_cmp_eq_u32 s62, s64
    s_cselect_b32 s62, s63, s62
    s_add_u32 m0, s73, 69632
    s_nop 0
    buffer_load_dwordx4 v6, s[24:27], s66 offen offset:0 lds
    buffer_load_dwordx4 v7, s[24:27], s66 offen offset:1024 lds
    buffer_load_dwordx4 v8, s[24:27], s66 offen offset:2048 lds
    buffer_load_dwordx4 v9, s[24:27], s66 offen offset:3072 lds
    s_add_u32 m0, m0, 4096
    s_mov_b32 exec_hi, 0
    buffer_load_dwordx4 v10, s[24:27], s66 offen lds
    s_mov_b32 exec_hi, -1
    s_add_u32 s66, s66, 589824
    s_cmp_eq_u32 s66, s68
    s_cselect_b32 s66, s67, s66
    ds_read_b128 v[32:35], v19 offset:0
    ds_read_b128 v[36:39], v19 offset:1024
    ds_read_b128 v[40:43], v19 offset:2048
    ds_read_b128 v[44:47], v19 offset:3072
    s_waitcnt vmcnt(9) lgkmcnt(0)
    s_barrier
    s_add_u32 m0, s71, 104448
    s_nop 0
    buffer_load_dwordx4 v2, s[20:23], s62 offen offset:0 lds
    buffer_load_dwordx4 v3, s[20:23], s62 offen offset:1024 lds
    buffer_load_dwordx4 v4, s[20:23], s62 offen offset:2048 lds
    buffer_load_dwordx4 v5, s[20:23], s62 offen offset:3072 lds
    s_add_u32 s62, s62, 128
    s_cmp_eq_u32 s62, s64
    s_cselect_b32 s62, s63, s62
    s_add_u32 m0, s73, 104448
    s_nop 0
    buffer_load_dwordx4 v6, s[24:27], s66 offen offset:0 lds
    buffer_load_dwordx4 v7, s[24:27], s66 offen offset:1024 lds
    buffer_load_dwordx4 v8, s[24:27], s66 offen offset:2048 lds
    buffer_load_dwordx4 v9, s[24:27], s66 offen offset:3072 lds
    s_add_u32 m0, m0, 4096
    s_mov_b32 exec_hi, 0
    buffer_load_dwordx4 v10, s[24:27], s66 offen lds
    s_mov_b32 exec_hi, -1
    s_add_u32 s66, s66, 589824
    s_cmp_eq_u32 s66, s68
    s_cselect_b32 s66, s67, s66
    ds_read_b128 v[48:51], v19 offset:34816
    ds_read_b128 v[52:55], v19 offset:35840
    ds_read_b128 v[56:59], v19 offset:36864
    ds_read_b128 v[60:63], v19 offset:37888
    s_waitcnt vmcnt(9) lgkmcnt(0)
    s_barrier
    s_add_u32 m0, s71, 0
    s_nop 0
    buffer_load_dwordx4 v2, s[20:23], s62 offen offset:0 lds
    buffer_load_dwordx4 v3, s[20:23], s62 offen offset:1024 lds
    buffer_load_dwordx4 v4, s[20:23], s62 offen offset:2048 lds
    buffer_load_dwordx4 v5, s[20:23], s62 offen offset:3072 lds
    s_add_u32 s62, s62, 128
    s_cmp_eq_u32 s62, s64
    s_cselect_b32 s62, s63, s62
    s_add_u32 m0, s73, 0
    s_nop 0
    buffer_load_dwordx4 v6, s[24:27], s66 offen offset:0 lds
    buffer_load_dwordx4 v7, s[24:27], s66 offen offset:1024 lds
    buffer_load_dwordx4 v8, s[24:27], s66 offen offset:2048 lds
    buffer_load_dwordx4 v9, s[24:27], s66 offen offset:3072 lds
    s_add_u32 m0, m0, 4096
    s_mov_b32 exec_hi, 0
    buffer_load_dwordx4 v10, s[24:27], s66 offen lds
    s_mov_b32 exec_hi, -1
    s_add_u32 s66, s66, 589824
    s_cmp_eq_u32 s66, s68
    s_cselect_b32 s66, s67, s66
    ds_read_b128 v[64:67], v20 offset:0
    ds_read_b128 v[68:71], v20 offset:1024
    ds_read_b128 v[72:75], v20 offset:2048
    ds_read_b128 v[76:79], v20 offset:3072
    s_waitcnt vmcnt(9) lgkmcnt(0)
    s_barrier
    s_add_u32 m0, s71, 34816
    s_nop 0
    buffer_load_dwordx4 v2, s[20:23], s62 offen offset:0 lds
    buffer_load_dwordx4 v3, s[20:23], s62 offen offset:1024 lds
    buffer_load_dwordx4 v4, s[20:23], s62 offen offset:2048 lds
    buffer_load_dwordx4 v5, s[20:23], s62 offen offset:3072 lds
    s_add_u32 s62, s62, 128
    s_cmp_eq_u32 s62, s64
    s_cselect_b32 s62, s63, s62
    s_add_u32 m0, s73, 34816
    s_nop 0
    buffer_load_dwordx4 v6, s[24:27], s66 offen offset:0 lds
    buffer_load_dwordx4 v7, s[24:27], s66 offen offset:1024 lds
    buffer_load_dwordx4 v8, s[24:27], s66 offen offset:2048 lds
    buffer_load_dwordx4 v9, s[24:27], s66 offen offset:3072 lds
    s_add_u32 m0, m0, 4096
    s_mov_b32 exec_hi, 0
    buffer_load_dwordx4 v10, s[24:27], s66 offen lds
    s_mov_b32 exec_hi, -1
    s_add_u32 s66, s66, 589824
    s_cmp_eq_u32 s66, s68
    s_cselect_b32 s66, s67, s66
    ds_read_b128 v[80:83], v20 offset:34816
    ds_read_b128 v[84:87], v20 offset:35840
    ds_read_b128 v[88:91], v20 offset:36864
    ds_read_b128 v[92:95], v20 offset:37888
    s_waitcnt vmcnt(9) lgkmcnt(0)
    s_barrier
    s_add_u32 m0, s71, 69632
    s_nop 0
    buffer_load_dwordx4 v2, s[20:23], s62 offen offset:0 lds
    buffer_load_dwordx4 v3, s[20:23], s62 offen offset:1024 lds
    buffer_load_dwordx4 v4, s[20:23], s62 offen offset:2048 lds
    buffer_load_dwordx4 v5, s[20:23], s62 offen offset:3072 lds
    s_add_u32 s62, s62, 128
    s_cmp_eq_u32 s62, s64
    s_cselect_b32 s62, s63, s62
    s_add_u32 m0, s73, 69632
    s_nop 0
    buffer_load_dwordx4 v6, s[24:27], s66 offen offset:0 lds
    buffer_load_dwordx4 v7, s[24:27], s66 offen offset:1024 lds
    buffer_load_dwordx4 v8, s[24:27], s66 offen offset:2048 lds
    buffer_load_dwordx4 v9, s[24:27], s66 offen offset:3072 lds
    s_add_u32 m0, m0, 4096
    s_mov_b32 exec_hi, 0
    buffer_load_dwordx4 v10, s[24:27], s66 offen lds
    s_mov_b32 exec_hi, -1
    s_add_u32 s66, s66, 589824
    s_cmp_eq_u32 s66, s68
    s_cselect_b32 s66, s67, s66
    ds_read_b128 v[96:99], v19 offset:0
    ds_read_b128 v[100:103], v19 offset:1024
    ds_read_b128 v[104:107], v19 offset:2048
    ds_read_b128 v[108:111], v19 offset:3072
    s_waitcnt vmcnt(9) lgkmcnt(0)
    s_barrier
    s_add_u32 m0, s71, 104448
    s_nop 0
    buffer_load_dwordx4 v2, s[20:23], s62 offen offset:0 lds
    buffer_load_dwordx4 v3, s[20:23], s62 offen offset:1024 lds
    buffer_load_dwordx4 v4, s[20:23], s62 offen offset:2048 lds
    buffer_load_dwordx4 v5, s[20:23], s62 offen offset:3072 lds
    s_add_u32 s62, s62, 128
    s_cmp_eq_u32 s62, s64
    s_cselect_b32 s62, s63, s62
    s_add_u32 m0, s73, 104448
    s_nop 0
    buffer_load_dwordx4 v6, s[24:27], s66 offen offset:0 lds
    buffer_load_dwordx4 v7, s[24:27], s66 offen offset:1024 lds
    buffer_load_dwordx4 v8, s[24:27], s66 offen offset:2048 lds
    buffer_load_dwordx4 v9, s[24:27], s66 offen offset:3072 lds
    s_add_u32 m0, m0, 4096
    s_mov_b32 exec_hi, 0
    buffer_load_dwordx4 v10, s[24:27], s66 offen lds
    s_mov_b32 exec_hi, -1
    s_add_u32 s66, s66, 589824
    s_cmp_eq_u32 s66, s68
    s_cselect_b32 s66, s67, s66
    s_waitcnt vmcnt(9) lgkmcnt(0)
    s_barrier
    s_add_u32 m0, s71, 0
    s_nop 0
    buffer_load_dwordx4 v2, s[20:23], s62 offen offset:0 lds
    buffer_load_dwordx4 v3, s[20:23], s62 offen offset:1024 lds
    buffer_load_dwordx4 v4, s[20:23], s62 offen offset:2048 lds
    buffer_load_dwordx4 v5, s[20:23], s62 offen offset:3072 lds
    s_add_u32 s62, s62, 128
    s_cmp_eq_u32 s62, s64
    s_cselect_b32 s62, s63, s62
    s_add_u32 m0, s73, 0
    s_nop 0
    buffer_load_dwordx4 v6, s[24:27], s66 offen offset:0 lds
    buffer_load_dwordx4 v7, s[24:27], s66 offen offset:1024 lds
    buffer_load_dwordx4 v8, s[24:27], s66 offen offset:2048 lds
    buffer_load_dwordx4 v9, s[24:27], s66 offen offset:3072 lds
    s_add_u32 m0, m0, 4096
    s_mov_b32 exec_hi, 0
    buffer_load_dwordx4 v10, s[24:27], s66 offen lds
    s_mov_b32 exec_hi, -1
    s_add_u32 s66, s66, 589824
    s_cmp_eq_u32 s66, s68
    s_cselect_b32 s66, s67, s66
    s_waitcnt vmcnt(9) lgkmcnt(0)
    s_barrier
    s_mul_i32 s57, s52, 147456
    s_mul_i32 s58, s54, 288
    s_add_u32 s57, s57, s58
    s_add_u32 s67, s57, 0
    s_add_u32 s68, s67, 5308416
    s_mul_i32 s66, s75, 589824
    s_add_u32 s66, s66, s67
    s_add_u32 s66, s66, 589824
    s_cmp_eq_u32 s66, s68
    s_cselect_b32 s66, s67, s66
    s_add_u32 s66, s66, 589824
    s_cmp_eq_u32 s66, s68
    s_cselect_b32 s66, s67, s66
    s_add_u32 s66, s66, 589824
    s_cmp_eq_u32 s66, s68
    s_cselect_b32 s66, s67, s66
    s_add_u32 s66, s66, 589824
    s_cmp_eq_u32 s66, s68
    s_cselect_b32 s66, s67, s66
    s_add_u32 s66, s66, 589824
    s_cmp_eq_u32 s66, s68
    s_cselect_b32 s66, s67, s66
    s_add_u32 m0, s73, 34816
    s_nop 0
    buffer_load_dwordx4 v6, s[24:27], s66 offen offset:0 lds
    buffer_load_dwordx4 v7, s[24:27], s66 offen offset:1024 lds
    buffer_load_dwordx4 v8, s[24:27], s66 offen offset:2048 lds
    buffer_load_dwordx4 v9, s[24:27], s66 offen offset:3072 lds
    s_add_u32 m0, m0, 4096
    s_mov_b32 exec_hi, 0
    buffer_load_dwordx4 v10, s[24:27], s66 offen lds
    s_mov_b32 exec_hi, -1
    s_add_u32 s66, s66, 589824
    s_cmp_eq_u32 s66, s68
    s_cselect_b32 s66, s67, s66
    s_waitcnt vmcnt(5) lgkmcnt(0)
    s_barrier
    s_add_u32 m0, s73, 69632
    s_nop 0
    buffer_load_dwordx4 v6, s[24:27], s66 offen offset:0 lds
    buffer_load_dwordx4 v7, s[24:27], s66 offen offset:1024 lds
    buffer_load_dwordx4 v8, s[24:27], s66 offen offset:2048 lds
    buffer_load_dwordx4 v9, s[24:27], s66 offen offset:3072 lds
    s_add_u32 m0, m0, 4096
    s_mov_b32 exec_hi, 0
    buffer_load_dwordx4 v10, s[24:27], s66 offen lds
    s_mov_b32 exec_hi, -1
    s_add_u32 s66, s66, 589824
    s_cmp_eq_u32 s66, s68
    s_cselect_b32 s66, s67, s66
    s_waitcnt vmcnt(5) lgkmcnt(0)
    s_barrier
    s_add_u32 m0, s73, 104448
    s_nop 0
    buffer_load_dwordx4 v6, s[24:27], s66 offen offset:0 lds
    buffer_load_dwordx4 v7, s[24:27], s66 offen offset:1024 lds
    buffer_load_dwordx4 v8, s[24:27], s66 offen offset:2048 lds
    buffer_load_dwordx4 v9, s[24:27], s66 offen offset:3072 lds
    s_add_u32 m0, m0, 4096
    s_mov_b32 exec_hi, 0
    buffer_load_dwordx4 v10, s[24:27], s66 offen lds
    s_mov_b32 exec_hi, -1
    s_add_u32 s66, s66, 589824
    s_cmp_eq_u32 s66, s68
    s_cselect_b32 s66, s67, s66
    s_add_u32 m0, s73, 0
    s_nop 0
    buffer_load_dwordx4 v6, s[24:27], s66 offen offset:0 lds
    buffer_load_dwordx4 v7, s[24:27], s66 offen offset:1024 lds
    buffer_load_dwordx4 v8, s[24:27], s66 offen offset:2048 lds
    buffer_load_dwordx4 v9, s[24:27], s66 offen offset:3072 lds
    s_add_u32 m0, m0, 4096
    s_mov_b32 exec_hi, 0
    buffer_load_dwordx4 v10, s[24:27], s66 offen lds
    s_mov_b32 exec_hi, -1
    s_add_u32 s66, s66, 589824
    s_cmp_eq_u32 s66, s68
    s_cselect_b32 s66, s67, s66
    s_cmp_ge_u32 s86, 72
    s_cbranch_scc1 L_lwf1
    s_add_u32 m0, s87, 0
    s_nop 0
    buffer_load_dwordx4 v132, s[44:47], s88 offen lds
    s_add_u32 m0, s87, 1024
    s_nop 0
    buffer_load_dwordx4 v133, s[44:47], s88 offen lds
    s_add_u32 m0, s87, 2048
    s_nop 0
    buffer_load_dwordx4 v134, s[44:47], s88 offen lds
    s_add_u32 m0, s87, 3072
    s_nop 0
    buffer_load_dwordx4 v135, s[44:47], s88 offen lds
    s_add_u32 m0, s87, 4096
    s_nop 0
    buffer_load_dwordx4 v136, s[44:47], s88 offen lds
L_lwf1:
    s_mov_b32 m0, 159744
    s_nop 0
    buffer_load_dwordx4 v15, s[28:31], s89 offen lds
    s_add_u32 s89, s89, 1024
    s_waitcnt vmcnt(11) lgkmcnt(0)
    s_barrier
    s_add_u32 m0, s73, 34816
    s_nop 0
    buffer_load_dwordx4 v6, s[24:27], s66 offen offset:0 lds
    buffer_load_dwordx4 v7, s[24:27], s66 offen offset:1024 lds
    buffer_load_dwordx4 v8, s[24:27], s66 offen offset:2048 lds
    buffer_load_dwordx4 v9, s[24:27], s66 offen offset:3072 lds
    s_add_u32 m0, m0, 4096
    s_mov_b32 exec_hi, 0
    buffer_load_dwordx4 v10, s[24:27], s66 offen lds
    s_mov_b32 exec_hi, -1
    s_add_u32 s66, s66, 589824
    s_cmp_eq_u32 s66, s68
    s_cselect_b32 s66, s67, s66
    ds_write_b128 v19, v[32:35] offset:34816
    ds_write_b128 v19, v[36:39] offset:35840
    ds_write_b128 v19, v[40:43] offset:36864
    ds_write_b128 v19, v[44:47] offset:37888
    s_cmp_ge_u32 s86, 72
    s_cbranch_scc1 L_lwf2
    v_lshrrev_b32 v138, 2, v0
    v_mul_u32_u24 v138, 144, v138
    v_and_b32 v139, 3, v0
    v_lshl_add_u32 v140, v139, 4, v138
    v_add_u32 v140, s87, v140
    v_and_b32 v139, 1, v0
    v_lshl_add_u32 v141, v139, 3, v138
    v_add_u32 v141, s87, v141
    s_waitcnt vmcnt(5)
    ds_read_b64_tr_b16 v[144:145], v140 offset:0
    ds_read_b64_tr_b16 v[146:147], v140 offset:2304
    ds_read_b64_tr_b16 v[148:149], v140 offset:8
    ds_read_b64_tr_b16 v[150:151], v140 offset:2312
    ds_read_b64_tr_b16 v[152:153], v140 offset:64
    ds_read_b64_tr_b16 v[154:155], v140 offset:2368
    ds_read_b64_tr_b16 v[156:157], v140 offset:72
    ds_read_b64_tr_b16 v[158:159], v140 offset:2376
    ds_read_b64_tr_b16 v[160:161], v141 offset:128
    ds_read_b64_tr_b16 v[162:163], v141 offset:2432
    s_mul_i32 s57, s90, 72
    s_add_u32 s57, s57, s86
    s_mul_i32 s57, s57, 4608
    s_add_u32 s57, s57, 18874368
    v_lshrrev_b32 v138, 4, v0
    v_lshlrev_b32 v138, 7, v138
    v_and_b32 v139, 7, v0
    v_lshl_add_u32 v138, v139, 4, v138
    v_add_u32 v138, 4096, v138
    s_waitcnt lgkmcnt(0)
    buffer_store_dwordx4 v[144:147], v15, s[32:35], s57 offen offset:0 sc1
    buffer_store_dwordx4 v[148:151], v15, s[32:35], s57 offen offset:1024 sc1
    buffer_store_dwordx4 v[152:155], v15, s[32:35], s57 offen offset:2048 sc1
    buffer_store_dwordx4 v[156:159], v15, s[32:35], s57 offen offset:3072 sc1
    s_mov_b32 s76, 0x00ff00ff
    s_mov_b32 s77, 0x00ff00ff
    s_mov_b64 exec, s[76:77]
    buffer_store_dwordx4 v[160:163], v138, s[32:35], s57 offen sc1
    s_mov_b64 exec, -1
L_lwf2:
    s_waitcnt vmcnt(11) lgkmcnt(0)
    s_barrier
    s_add_u32 m0, s73, 69632
    s_nop 0
    buffer_load_dwordx4 v6, s[24:27], s66 offen offset:0 lds
    buffer_load_dwordx4 v7, s[24:27], s66 offen offset:1024 lds
    buffer_load_dwordx4 v8, s[24:27], s66 offen offset:2048 lds
    buffer_load_dwordx4 v9, s[24:27], s66 offen offset:3072 lds
    s_add_u32 m0, m0, 4096
    s_mov_b32 exec_hi, 0
    buffer_load_dwordx4 v10, s[24:27], s66 offen lds
    s_mov_b32 exec_hi, -1
    s_add_u32 s66, s66, 589824
    s_cmp_eq_u32 s66, s68
    s_cselect_b32 s66, s67, s66
    ds_write_b128 v20, v[48:51] offset:0
    ds_write_b128 v20, v[52:55] offset:1024
    ds_write_b128 v20, v[56:59] offset:2048
    ds_write_b128 v20, v[60:63] offset:3072
    s_waitcnt vmcnt(11) lgkmcnt(4)
    s_barrier
    s_add_u32 m0, s73, 104448
    s_nop 0
    buffer_load_dwordx4 v6, s[24:27], s66 offen offset:0 lds
    buffer_load_dwordx4 v7, s[24:27], s66 offen offset:1024 lds
    buffer_load_dwordx4 v8, s[24:27], s66 offen offset:2048 lds
    buffer_load_dwordx4 v9, s[24:27], s66 offen offset:3072 lds
    s_add_u32 m0, m0, 4096
    s_mov_b32 exec_hi, 0
    buffer_load_dwordx4 v10, s[24:27], s66 offen lds
    s_mov_b32 exec_hi, -1
    s_add_u32 s66, s66, 589824
    s_cmp_eq_u32 s66, s68
    s_cselect_b32 s66, s67, s66
    ds_write_b128 v20, v[64:67] offset:34816
    ds_write_b128 v20, v[68:71] offset:35840
    ds_write_b128 v20, v[72:75] offset:36864
    ds_write_b128 v20, v[76:79] offset:37888
    s_waitcnt vmcnt(10)
    s_waitcnt vmcnt(10) lgkmcnt(4)
    s_barrier
    s_add_u32 m0, s73, 0
    s_nop 0
    buffer_load_dwordx4 v6, s[24:27], s66 offen offset:0 lds
    buffer_load_dwordx4 v7, s[24:27], s66 offen offset:1024 lds
    buffer_load_dwordx4 v8, s[24:27], s66 offen offset:2048 lds
    buffer_load_dwordx4 v9, s[24:27], s66 offen offset:3072 lds
    s_add_u32 m0, m0, 4096
    s_mov_b32 exec_hi, 0
    buffer_load_dwordx4 v10, s[24:27], s66 offen lds
    s_mov_b32 exec_hi, -1
    s_add_u32 s66, s66, 589824
    s_cmp_eq_u32 s66, s68
    s_cselect_b32 s66, s67, s66
    ds_write_b128 v19, v[80:83] offset:0
    ds_write_b128 v19, v[84:87] offset:1024
    ds_write_b128 v19, v[88:91] offset:2048
    ds_write_b128 v19, v[92:95] offset:3072
    s_mov_b32 m0, 159744
    s_nop 0
    buffer_load_dwordx4 v15, s[28:31], s89 offen lds
    s_add_u32 s89, s89, 1024
    buffer_load_dwordx4 v15, s[28:31], s89 offen lds
    s_add_u32 s89, s89, 1024
    buffer_load_dwordx4 v15, s[28:31], s89 offen lds
    s_add_u32 s89, s89, 1024
    s_waitcnt vmcnt(13) lgkmcnt(4)
    s_barrier
    s_add_u32 m0, s73, 34816
    s_nop 0
    buffer_load_dwordx4 v6, s[24:27], s66 offen offset:0 lds
    buffer_load_dwordx4 v7, s[24:27], s66 offen offset:1024 lds
    buffer_load_dwordx4 v8, s[24:27], s66 offen offset:2048 lds
    buffer_load_dwordx4 v9, s[24:27], s66 offen offset:3072 lds
    s_add_u32 m0, m0, 4096
    s_mov_b32 exec_hi, 0
    buffer_load_dwordx4 v10, s[24:27], s66 offen lds
    s_mov_b32 exec_hi, -1
    s_add_u32 s66, s66, 589824
    s_cmp_eq_u32 s66, s68
    s_cselect_b32 s66, s67, s66
    ds_write_b128 v19, v[96:99] offset:34816
    ds_write_b128 v19, v[100:103] offset:35840
    ds_write_b128 v19, v[104:107] offset:36864
    ds_write_b128 v19, v[108:111] offset:37888
    s_mov_b32 m0, 159744
    s_nop 0
    buffer_load_dwordx4 v15, s[28:31], s89 offen lds
    s_add_u32 s89, s89, 1024
    buffer_load_dwordx4 v15, s[28:31], s89 offen lds
    s_add_u32 s89, s89, 1024
    s_lshl_b32 s75, s55, 2
    s_mov_b32 s63, 0
    s_add_u32 s64, s63, 4096
    s_mul_i32 s62, s75, 128
    s_add_u32 s62, s62, s63
    s_mul_i32 s57, s54, 589824
    s_mul_i32 s58, s52, 4608
    s_add_u32 s57, s57, s58
    s_add_u32 s67, s57, 0
    s_add_u32 s68, s67, 589824
    s_mul_i32 s66, s75, 18432
    s_add_u32 s66, s66, s67
    s_waitcnt vmcnt(15) lgkmcnt(4)
    s_barrier
    s_mov_b32 m0, 159744
    s_nop 0
    buffer_load_dwordx4 v15, s[28:31], s89 offen lds
    s_add_u32 s89, s89, 1024
    buffer_load_dwordx4 v15, s[28:31], s89 offen lds
    s_add_u32 s89, s89, 1024
    s_add_u32 m0, s71, 69632
    s_nop 0
    buffer_load_dwordx4 v11, s[28:31], s62 offen offset:0 lds
    buffer_load_dwordx4 v12, s[28:31], s62 offen offset:1024 lds
    buffer_load_dwordx4 v13, s[28:31], s62 offen offset:2048 lds
    buffer_load_dwordx4 v14, s[28:31], s62 offen offset:3072 lds
    s_add_u32 s62, s62, 128
    s_cmp_eq_u32 s62, s64
    s_cselect_b32 s62, s63, s62
    s_waitcnt vmcnt(16) lgkmcnt(0)
    s_barrier
    s_add_u32 m0, s71, 104448
    s_nop 0
    buffer_load_dwordx4 v11, s[28:31], s62 offen offset:0 lds
    buffer_load_dwordx4 v12, s[28:31], s62 offen offset:1024 lds
    buffer_load_dwordx4 v13, s[28:31], s62 offen offset:2048 lds
    buffer_load_dwordx4 v14, s[28:31], s62 offen offset:3072 lds
    s_add_u32 s62, s62, 128
    s_cmp_eq_u32 s62, s64
    s_cselect_b32 s62, s63, s62
    s_waitcnt vmcnt(12) lgkmcnt(0)
    s_barrier
    s_add_u32 m0, s71, 0
    s_nop 0
    buffer_load_dwordx4 v11, s[28:31], s62 offen offset:0 lds
    buffer_load_dwordx4 v12, s[28:31], s62 offen offset:1024 lds
    buffer_load_dwordx4 v13, s[28:31], s62 offen offset:2048 lds
    buffer_load_dwordx4 v14, s[28:31], s62 offen offset:3072 lds
    s_add_u32 s62, s62, 128
    s_cmp_eq_u32 s62, s64
    s_cselect_b32 s62, s63, s62
    s_lshl_b32 s58, s54, 10
    s_add_u32 s58, s58, 22544384
    s_xor_b32 s59, s58, 8192
    v_mov_b32 v240, 0
    s_mov_b32 s70, 400000
L_poll_1:
    buffer_load_dword v241, v240, s[40:43], 0 offen sc1
    buffer_load_dword v242, v17, s[32:35], s58 offen sc1
    buffer_load_dword v243, v17, s[32:35], s59 offen sc1
    s_waitcnt vmcnt(0)
    v_cmp_eq_u32 vcc, 0, v241
    v_cmp_ne_u32 s[78:79], v241, v242
    s_or_b64 vcc, vcc, s[78:79]
    v_cmp_ne_u32 s[78:79], v241, v243
    s_or_b64 vcc, vcc, s[78:79]
    s_cbranch_scc0 L_polld_2
    s_sub_u32 s70, s70, 1
    s_cmp_eq_u32 s70, 0
    s_cbranch_scc1 L_polld_2
    s_sleep 1
    s_branch L_poll_1
L_polld_2:
    s_add_u32 m0, s73, 69632
    s_nop 0
    buffer_load_dwordx4 v15, s[32:35], s66 offen offset:0 sc1 lds
    buffer_load_dwordx4 v15, s[32:35], s66 offen offset:1024 sc1 lds
    buffer_load_dwordx4 v15, s[32:35], s66 offen offset:2048 sc1 lds
    buffer_load_dwordx4 v15, s[32:35], s66 offen offset:3072 sc1 lds
    s_add_u32 m0, m0, 4096
    s_mov_b32 exec_hi, 0
    buffer_load_dwordx4 v16, s[32:35], s66 offen sc1 lds
    s_mov_b32 exec_hi, -1
    s_add_u32 s66, s66, 18432
    s_cmp_eq_u32 s66, s68
    s_cselect_b32 s66, s67, s66
    s_add_u32 m0, s73, 104448
    s_nop 0
    buffer_load_dwordx4 v15, s[32:35], s66 offen offset:0 sc1 lds
    buffer_load_dwordx4 v15, s[32:35], s66 offen offset:1024 sc1 lds
    buffer_load_dwordx4 v15, s[32:35], s66 offen offset:2048 sc1 lds
    buffer_load_dwordx4 v15, s[32:35], s66 offen offset:3072 sc1 lds
    s_add_u32 m0, m0, 4096
    s_mov_b32 exec_hi, 0
    buffer_load_dwordx4 v16, s[32:35], s66 offen sc1 lds
    s_mov_b32 exec_hi, -1
    s_add_u32 s66, s66, 18432
    s_cmp_eq_u32 s66, s68
    s_cselect_b32 s66, s67, s66
    s_add_u32 m0, s73, 0
    s_nop 0
    buffer_load_dwordx4 v15, s[32:35], s66 offen offset:0 sc1 lds
    buffer_load_dwordx4 v15, s[32:35], s66 offen offset:1024 sc1 lds
    buffer_load_dwordx4 v15, s[32:35], s66 offen offset:2048 sc1 lds
    buffer_load_dwordx4 v15, s[32:35], s66 offen offset:3072 sc1 lds
    s_add_u32 m0, m0, 4096
    s_mov_b32 exec_hi, 0
    buffer_load_dwordx4 v16, s[32:35], s66 offen sc1 lds
    s_mov_b32 exec_hi, -1
    s_add_u32 s66, s66, 18432
    s_cmp_eq_u32 s66, s68
    s_cselect_b32 s66, s67, s66
    s_waitcnt vmcnt(10) lgkmcnt(0)
    s_barrier
    s_add_u32 m0, s71, 34816
    s_nop 0
    buffer_load_dwordx4 v11, s[28:31], s62 offen offset:0 lds
    buffer_load_dwordx4 v12, s[28:31], s62 offen offset:1024 lds
    buffer_load_dwordx4 v13, s[28:31], s62 offen offset:2048 lds
    buffer_load_dwordx4 v14, s[28:31], s62 offen offset:3072 lds
    s_add_u32 s62, s62, 128
    s_cmp_eq_u32 s62, s64
    s_cselect_b32 s62, s63, s62
    s_add_u32 m0, s73, 34816
    s_nop 0
    buffer_load_dwordx4 v15, s[32:35], s66 offen offset:0 sc1 lds
    buffer_load_dwordx4 v15, s[32:35], s66 offen offset:1024 sc1 lds
    buffer_load_dwordx4 v15, s[32:35], s66 offen offset:2048 sc1 lds
    buffer_load_dwordx4 v15, s[32:35], s66 offen offset:3072 sc1 lds
    s_add_u32 m0, m0, 4096
    s_mov_b32 exec_hi, 0
    buffer_load_dwordx4 v16, s[32:35], s66 offen sc1 lds
    s_mov_b32 exec_hi, -1
    s_add_u32 s66, s66, 18432
    s_cmp_eq_u32 s66, s68
    s_cselect_b32 s66, s67, s66
    s_waitcnt vmcnt(14) lgkmcnt(0)
    s_barrier
    s_add_u32 m0, s71, 69632
    s_nop 0
    buffer_load_dwordx4 v11, s[28:31], s62 offen offset:0 lds
    buffer_load_dwordx4 v12, s[28:31], s62 offen offset:1024 lds
    buffer_load_dwordx4 v13, s[28:31], s62 offen offset:2048 lds
    buffer_load_dwordx4 v14, s[28:31], s62 offen offset:3072 lds
    s_add_u32 s62, s62, 128
    s_cmp_eq_u32 s62, s64
    s_cselect_b32 s62, s63, s62
    s_add_u32 m0, s73, 69632
    s_nop 0
    buffer_load_dwordx4 v15, s[32:35], s66 offen offset:0 sc1 lds
    buffer_load_dwordx4 v15, s[32:35], s66 offen offset:1024 sc1 lds
    buffer_load_dwordx4 v15, s[32:35], s66 offen offset:2048 sc1 lds
    buffer_load_dwordx4 v15, s[32:35], s66 offen offset:3072 sc1 lds
    s_add_u32 m0, m0, 4096
    s_mov_b32 exec_hi, 0
    buffer_load_dwordx4 v16, s[32:35], s66 offen sc1 lds
    s_mov_b32 exec_hi, -1
    s_add_u32 s66, s66, 18432
    s_cmp_eq_u32 s66, s68
    s_cselect_b32 s66, s67, s66
    s_waitcnt vmcnt(18) lgkmcnt(0)
    s_barrier
    s_add_u32 m0, s71, 104448
    s_nop 0
    buffer_load_dwordx4 v11, s[28:31], s62 offen offset:0 lds
    buffer_load_dwordx4 v12, s[28:31], s62 offen offset:1024 lds
    buffer_load_dwordx4 v13, s[28:31], s62 offen offset:2048 lds
    buffer_load_dwordx4 v14, s[28:31], s62 offen offset:3072 lds
    s_add_u32 s62, s62, 128
    s_cmp_eq_u32 s62, s64
    s_cselect_b32 s62, s63, s62
    s_add_u32 m0, s73, 104448
    s_nop 0
    buffer_load_dwordx4 v15, s[32:35], s66 offen offset:0 sc1 lds
    buffer_load_dwordx4 v15, s[32:35], s66 offen offset:1024 sc1 lds
    buffer_load_dwordx4 v15, s[32:35], s66 offen offset:2048 sc1 lds
    buffer_load_dwordx4 v15, s[32:35], s66 offen offset:3072 sc1 lds
    s_add_u32 m0, m0, 4096
    s_mov_b32 exec_hi, 0
    buffer_load_dwordx4 v16, s[32:35], s66 offen sc1 lds
    s_mov_b32 exec_hi, -1
    s_add_u32 s66, s66, 18432
    s_cmp_eq_u32 s66, s68
    s_cselect_b32 s66, s67, s66
    s_mov_b32 s61, s71
    s_mov_b32 s65, s73
    s_mov_b32 s69, 26
L_ldC:
    s_waitcnt vmcnt(18)
    s_barrier
    s_mov_b32 m0, s61
    s_nop 0
    buffer_load_dwordx4 v11, s[28:31], s62 offen offset:0 lds
    buffer_load_dwordx4 v12, s[28:31], s62 offen offset:1024 lds
    buffer_load_dwordx4 v13, s[28:31], s62 offen offset:2048 lds
    buffer_load_dwordx4 v14, s[28:31], s62 offen offset:3072 lds
    s_add_u32 s61, s61, 34816
    s_cmp_eq_u32 s61, s72
    s_cselect_b32 s61, s71, s61
    s_add_u32 s62, s62, 128
    s_cmp_eq_u32 s62, s64
    s_cselect_b32 s62, s63, s62
    s_mov_b32 m0, s65
    s_nop 0
    buffer_load_dwordx4 v15, s[32:35], s66 offen offset:0 sc1 lds
    buffer_load_dwordx4 v15, s[32:35], s66 offen offset:1024 sc1 lds
    buffer_load_dwordx4 v15, s[32:35], s66 offen offset:2048 sc1 lds
    buffer_load_dwordx4 v15, s[32:35], s66 offen offset:3072 sc1 lds
    s_add_u32 m0, m0, 4096
    s_mov_b32 exec_hi, 0
    buffer_load_dwordx4 v16, s[32:35], s66 offen sc1 lds
    s_mov_b32 exec_hi, -1
    s_add_u32 s65, s65, 34816
    s_cmp_eq_u32 s65, s74
    s_cselect_b32 s65, s73, s65
    s_add_u32 s66, s66, 18432
    s_cmp_eq_u32 s66, s68
    s_cselect_b32 s66, s67, s66
    s_sub_u32 s69, s69, 1
    s_cmp_lg_u32 s69, 0
    s_cbranch_scc1 L_ldC
    s_lshl_b32 s75, s55, 1
    s_lshl_b32 s57, s84, 1
    s_lshr_b32 s58, s52, 1
    s_add_u32 s57, s57, s58
    s_lshl_b32 s69, s57, 7
    s_add_u32 s69, s69, 22609920
    s_mul_i32 s57, s57, 147456
    s_and_b32 s58, s52, 1
    s_lshl_b32 s58, s58, 12
    s_add_u32 s57, s57, s58
    s_add_u32 s63, s57, 9437184
    s_add_u32 s64, s63, 147456
    s_mul_i32 s62, s75, 8192
    s_add_u32 s62, s62, s63
    s_mul_i32 s67, s85, 331776
    s_mul_i32 s58, s52, 4608
    s_add_u32 s67, s67, s58
    s_add_u32 s67, s67, 18874368
    s_mul_i32 s65, s52, 4608
    s_waitcnt vmcnt(18) lgkmcnt(0)
    s_barrier
    s_add_u32 s66, s75, 0
    s_sub_u32 s58, s66, 18
    s_cmp_ge_u32 s66, 18
    s_cselect_b32 s66, s58, s66
    s_mul_i32 s66, s66, 18432
    s_add_u32 s66, s66, s67
    s_add_u32 m0, s65, 83968
    s_nop 0
    buffer_load_dwordx4 v15, s[32:35], s66 offen offset:0 sc1 lds
    buffer_load_dwordx4 v15, s[32:35], s66 offen offset:1024 sc1 lds
    buffer_load_dwordx4 v15, s[32:35], s66 offen offset:2048 sc1 lds
    buffer_load_dwordx4 v15, s[32:35], s66 offen offset:3072 sc1 lds
    s_add_u32 m0, m0, 4096
    s_mov_b32 exec_hi, 0
    buffer_load_dwordx4 v16, s[32:35], s66 offen sc1 lds
    s_mov_b32 exec_hi, -1
    s_add_u32 s66, s75, 3
    s_sub_u32 s58, s66, 18
    s_cmp_ge_u32 s66, 18
    s_cselect_b32 s66, s58, s66
    s_mul_i32 s66, s66, 18432
    s_add_u32 s66, s66, s67
    s_add_u32 m0, s65, 139264
    s_nop 0
    buffer_load_dwordx4 v15, s[32:35], s66 offen offset:0 sc1 lds
    buffer_load_dwordx4 v15, s[32:35], s66 offen offset:1024 sc1 lds
    buffer_load_dwordx4 v15, s[32:35], s66 offen offset:2048 sc1 lds
    buffer_load_dwordx4 v15, s[32:35], s66 offen offset:3072 sc1 lds
    s_add_u32 m0, m0, 4096
    s_mov_b32 exec_hi, 0
    buffer_load_dwordx4 v16, s[32:35], s66 offen sc1 lds
    s_mov_b32 exec_hi, -1
    s_waitcnt vmcnt(10) lgkmcnt(0)
    s_barrier
    s_add_u32 s66, s75, 1
    s_sub_u32 s58, s66, 18
    s_cmp_ge_u32 s66, 18
    s_cselect_b32 s66, s58, s66
    s_mul_i32 s66, s66, 18432
    s_add_u32 s66, s66, s67
    s_add_u32 m0, s65, 102400
    s_nop 0
    buffer_load_dwordx4 v15, s[32:35], s66 offen offset:0 sc1 lds
    buffer_load_dwordx4 v15, s[32:35], s66 offen offset:1024 sc1 lds
    buffer_load_dwordx4 v15, s[32:35], s66 offen offset:2048 sc1 lds
    buffer_load_dwordx4 v15, s[32:35], s66 offen offset:3072 sc1 lds
    s_add_u32 m0, m0, 4096
    s_mov_b32 exec_hi, 0
    buffer_load_dwordx4 v16, s[32:35], s66 offen sc1 lds
    s_mov_b32 exec_hi, -1
    s_add_u32 s66, s75, 2
    s_sub_u32 s58, s66, 18
    s_cmp_ge_u32 s66, 18
    s_cselect_b32 s66, s58, s66
    s_mul_i32 s66, s66, 18432
    s_add_u32 s66, s66, s67
    s_add_u32 m0, s65, 120832
    s_nop 0
    buffer_load_dwordx4 v15, s[32:35], s66 offen offset:0 sc1 lds
    buffer_load_dwordx4 v15, s[32:35], s66 offen offset:1024 sc1 lds
    buffer_load_dwordx4 v15, s[32:35], s66 offen offset:2048 sc1 lds
    buffer_load_dwordx4 v15, s[32:35], s66 offen offset:3072 sc1 lds
    s_add_u32 m0, m0, 4096
    s_mov_b32 exec_hi, 0
    buffer_load_dwordx4 v16, s[32:35], s66 offen sc1 lds
    s_mov_b32 exec_hi, -1
    s_waitcnt vmcnt(0)
    s_barrier
    s_add_u32 s66, s75, 4
    s_sub_u32 s58, s66, 18
    s_cmp_ge_u32 s66, 18
    s_cselect_b32 s66, s58, s66
    s_mul_i32 s66, s66, 18432
    s_add_u32 s66, s66, s67
    s_add_u32 m0, s65, 65536
    s_nop 0
    buffer_load_dwordx4 v15, s[32:35], s66 offen offset:0 sc1 lds
    buffer_load_dwordx4 v15, s[32:35], s66 offen offset:1024 sc1 lds
    buffer_load_dwordx4 v15, s[32:35], s66 offen offset:2048 sc1 lds
    buffer_load_dwordx4 v15, s[32:35], s66 offen offset:3072 sc1 lds
    s_add_u32 m0, m0, 4096
    s_mov_b32 exec_hi, 0
    buffer_load_dwordx4 v16, s[32:35], s66 offen sc1 lds
    s_mov_b32 exec_hi, -1
    s_barrier
    s_add_u32 s66, s75, 5
    s_sub_u32 s58, s66, 18
    s_cmp_ge_u32 s66, 18
    s_cselect_b32 s66, s58, s66
    s_mul_i32 s66, s66, 18432
    s_add_u32 s66, s66, s67
    s_add_u32 m0, s65, 83968
    s_nop 0
    buffer_load_dwordx4 v15, s[32:35], s66 offen offset:0 sc1 lds
    buffer_load_dwordx4 v15, s[32:35], s66 offen offset:1024 sc1 lds
    buffer_load_dwordx4 v15, s[32:35], s66 offen offset:2048 sc1 lds
    buffer_load_dwordx4 v15, s[32:35], s66 offen offset:3072 sc1 lds
    s_add_u32 m0, m0, 4096
    s_mov_b32 exec_hi, 0
    buffer_load_dwordx4 v16, s[32:35], s66 offen sc1 lds
    s_mov_b32 exec_hi, -1
    s_add_u32 s66, s75, 6
    s_sub_u32 s58, s66, 18
    s_cmp_ge_u32 s66, 18
    s_cselect_b32 s66, s58, s66
    s_mul_i32 s66, s66, 18432
    s_add_u32 s66, s66, s67
    s_add_u32 m0, s65, 102400
    s_nop 0
    buffer_load_dwordx4 v15, s[32:35], s66 offen offset:0 sc1 lds
    buffer_load_dwordx4 v15, s[32:35], s66 offen offset:1024 sc1 lds
    buffer_load_dwordx4 v15, s[32:35], s66 offen offset:2048 sc1 lds
    buffer_load_dwordx4 v15, s[32:35], s66 offen offset:3072 sc1 lds
    s_add_u32 m0, m0, 4096
    s_mov_b32 exec_hi, 0
    buffer_load_dwordx4 v16, s[32:35], s66 offen sc1 lds
    s_mov_b32 exec_hi, -1
    v_mov_b32 v240, 0
    s_mov_b32 s70, 400000
L_poll_3:
    buffer_load_dword v241, v240, s[40:43], 0 offen sc1
    buffer_load_dword v242, v18, s[32:35], s69 offen sc1
    s_waitcnt vmcnt(0)
    v_cmp_eq_u32 vcc, 0, v241
    v_cmp_ne_u32 s[78:79], v241, v242
    s_or_b64 vcc, vcc, s[78:79]
    s_cbranch_scc0 L_polld_4
    s_sub_u32 s70, s70, 1
    s_cmp_eq_u32 s70, 0
    s_cbranch_scc1 L_polld_4
    s_sleep 1
    s_branch L_poll_3
L_polld_4:
    s_add_u32 m0, s71, 0
    s_nop 0
    buffer_load_dwordx4 v15, s[32:35], s62 offen offset:0 sc1 lds
    buffer_load_dwordx4 v15, s[32:35], s62 offen offset:1024 sc1 lds
    buffer_load_dwordx4 v15, s[32:35], s62 offen offset:2048 sc1 lds
    buffer_load_dwordx4 v15, s[32:35], s62 offen offset:3072 sc1 lds
    s_add_u32 s62, s62, 8192
    s_cmp_eq_u32 s62, s64
    s_cselect_b32 s62, s63, s62
    s_add_u32 m0, s71, 16384
    s_nop 0
    buffer_load_dwordx4 v15, s[32:35], s62 offen offset:0 sc1 lds
    buffer_load_dwordx4 v15, s[32:35], s62 offen offset:1024 sc1 lds
    buffer_load_dwordx4 v15, s[32:35], s62 offen offset:2048 sc1 lds
    buffer_load_dwordx4 v15, s[32:35], s62 offen offset:3072 sc1 lds
    s_add_u32 s62, s62, 8192
    s_cmp_eq_u32 s62, s64
    s_cselect_b32 s62, s63, s62
    s_add_u32 m0, s71, 32768
    s_nop 0
    buffer_load_dwordx4 v15, s[32:35], s62 offen offset:0 sc1 lds
    buffer_load_dwordx4 v15, s[32:35], s62 offen offset:1024 sc1 lds
    buffer_load_dwordx4 v15, s[32:35], s62 offen offset:2048 sc1 lds
    buffer_load_dwordx4 v15, s[32:35], s62 offen offset:3072 sc1 lds
    s_add_u32 s62, s62, 8192
    s_cmp_eq_u32 s62, s64
    s_cselect_b32 s62, s63, s62
    s_add_u32 m0, s71, 49152
    s_nop 0
    buffer_load_dwordx4 v15, s[32:35], s62 offen offset:0 sc1 lds
    buffer_load_dwordx4 v15, s[32:35], s62 offen offset:1024 sc1 lds
    buffer_load_dwordx4 v15, s[32:35], s62 offen offset:2048 sc1 lds
    buffer_load_dwordx4 v15, s[32:35], s62 offen offset:3072 sc1 lds
    s_add_u32 s62, s62, 8192
    s_cmp_eq_u32 s62, s64
    s_cselect_b32 s62, s63, s62
    s_waitcnt vmcnt(12) lgkmcnt(0)
    s_barrier
    s_add_u32 s66, s75, 7
    s_sub_u32 s58, s66, 18
    s_cmp_ge_u32 s66, 18
    s_cselect_b32 s66, s58, s66
    s_mul_i32 s66, s66, 18432
    s_add_u32 s66, s66, s67
    s_add_u32 m0, s65, 120832
    s_nop 0
    buffer_load_dwordx4 v15, s[32:35], s66 offen offset:0 sc1 lds
    buffer_load_dwordx4 v15, s[32:35], s66 offen offset:1024 sc1 lds
    buffer_load_dwordx4 v15, s[32:35], s66 offen offset:2048 sc1 lds
    s_add_u32 s66, s75, 7
    s_sub_u32 s58, s66, 18
    s_cmp_ge_u32 s66, 18
    s_cselect_b32 s66, s58, s66
    s_mul_i32 s66, s66, 18432
    s_add_u32 s66, s66, s67
    s_add_u32 m0, s65, 120832
    s_nop 0
    buffer_load_dwordx4 v15, s[32:35], s66 offen offset:3072 sc1 lds
    s_add_u32 m0, m0, 4096
    s_mov_b32 exec_hi, 0
    buffer_load_dwordx4 v16, s[32:35], s66 offen sc1 lds
    s_mov_b32 exec_hi, -1
    s_waitcnt vmcnt(13) lgkmcnt(0)
    s_barrier
    s_add_u32 m0, s71, 0
    s_nop 0
    buffer_load_dwordx4 v15, s[32:35], s62 offen offset:0 sc1 lds
    buffer_load_dwordx4 v15, s[32:35], s62 offen offset:1024 sc1 lds
    buffer_load_dwordx4 v15, s[32:35], s62 offen offset:2048 sc1 lds
    buffer_load_dwordx4 v15, s[32:35], s62 offen offset:3072 sc1 lds
    s_add_u32 s62, s62, 8192
    s_cmp_eq_u32 s62, s64
    s_cselect_b32 s62, s63, s62
    s_add_u32 s66, s75, 8
    s_sub_u32 s58, s66, 18
    s_cmp_ge_u32 s66, 18
    s_cselect_b32 s66, s58, s66
    s_mul_i32 s66, s66, 18432
    s_add_u32 s66, s66, s67
    s_add_u32 m0, s65, 139264
    s_nop 0
    buffer_load_dwordx4 v15, s[32:35], s66 offen offset:0 sc1 lds
    buffer_load_dwordx4 v15, s[32:35], s66 offen offset:1024 sc1 lds
    buffer_load_dwordx4 v15, s[32:35], s66 offen offset:2048 sc1 lds
    s_waitcnt vmcnt(16) lgkmcnt(0)
    s_barrier
    s_add_u32 m0, s71, 16384
    s_nop 0
    buffer_load_dwordx4 v15, s[32:35], s62 offen offset:0 sc1 lds
    buffer_load_dwordx4 v15, s[32:35], s62 offen offset:1024 sc1 lds
    buffer_load_dwordx4 v15, s[32:35], s62 offen offset:2048 sc1 lds
    buffer_load_dwordx4 v15, s[32:35], s62 offen offset:3072 sc1 lds
    s_add_u32 s62, s62, 8192
    s_cmp_eq_u32 s62, s64
    s_cselect_b32 s62, s63, s62
    s_add_u32 s66, s75, 8
    s_sub_u32 s58, s66, 18
    s_cmp_ge_u32 s66, 18
    s_cselect_b32 s66, s58, s66
    s_mul_i32 s66, s66, 18432
    s_add_u32 s66, s66, s67
    s_add_u32 m0, s65, 139264
    s_nop 0
    buffer_load_dwordx4 v15, s[32:35], s66 offen offset:3072 sc1 lds
    s_add_u32 m0, m0, 4096
    s_mov_b32 exec_hi, 0
    buffer_load_dwordx4 v16, s[32:35], s66 offen sc1 lds
    s_mov_b32 exec_hi, -1
    s_waitcnt vmcnt(18) lgkmcnt(0)
    s_barrier
    s_add_u32 m0, s71, 32768
    s_nop 0
    buffer_load_dwordx4 v15, s[32:35], s62 offen offset:0 sc1 lds
    buffer_load_dwordx4 v15, s[32:35], s62 offen offset:1024 sc1 lds
    buffer_load_dwordx4 v15, s[32:35], s62 offen offset:2048 sc1 lds
    buffer_load_dwordx4 v15, s[32:35], s62 offen offset:3072 sc1 lds
    s_add_u32 s62, s62, 8192
    s_cmp_eq_u32 s62, s64
    s_cselect_b32 s62, s63, s62
    s_add_u32 s66, s75, 9
    s_sub_u32 s58, s66, 18
    s_cmp_ge_u32 s66, 18
    s_cselect_b32 s66, s58, s66
    s_mul_i32 s66, s66, 18432
    s_add_u32 s66, s66, s67
    s_add_u32 m0, s65, 65536
    s_nop 0
    buffer_load_dwordx4 v15, s[32:35], s66 offen offset:0 sc1 lds
    buffer_load_dwordx4 v15, s[32:35], s66 offen offset:1024 sc1 lds
    buffer_load_dwordx4 v15, s[32:35], s66 offen offset:2048 sc1 lds
    s_add_u32 s66, s75, 9
    s_sub_u32 s58, s66, 18
    s_cmp_ge_u32 s66, 18
    s_cselect_b32 s66, s58, s66
    s_mul_i32 s66, s66, 18432
    s_add_u32 s66, s66, s67
    s_add_u32 m0, s65, 65536
    s_nop 0
    buffer_load_dwordx4 v15, s[32:35], s66 offen offset:3072 sc1 lds
    s_add_u32 m0, m0, 4096
    s_mov_b32 exec_hi, 0
    buffer_load_dwordx4 v16, s[32:35], s66 offen sc1 lds
    s_mov_b32 exec_hi, -1
    s_waitcnt vmcnt(18) lgkmcnt(0)
    s_barrier
    s_add_u32 m0, s71, 49152
    s_nop 0
    buffer_load_dwordx4 v15, s[32:35], s62 offen offset:0 sc1 lds
    buffer_load_dwordx4 v15, s[32:35], s62 offen offset:1024 sc1 lds
    buffer_load_dwordx4 v15, s[32:35], s62 offen offset:2048 sc1 lds
    buffer_load_dwordx4 v15, s[32:35], s62 offen offset:3072 sc1 lds
    s_add_u32 s62, s62, 8192
    s_cmp_eq_u32 s62, s64
    s_cselect_b32 s62, s63, s62
    s_add_u32 s66, s75, 10
    s_sub_u32 s58, s66, 18
    s_cmp_ge_u32 s66, 18
    s_cselect_b32 s66, s58, s66
    s_mul_i32 s66, s66, 18432
    s_add_u32 s66, s66, s67
    s_add_u32 m0, s65, 83968
    s_nop 0
    buffer_load_dwordx4 v15, s[32:35], s66 offen offset:0 sc1 lds
    buffer_load_dwordx4 v15, s[32:35], s66 offen offset:1024 sc1 lds
    buffer_load_dwordx4 v15, s[32:35], s66 offen offset:2048 sc1 lds
    s_waitcnt vmcnt(18) lgkmcnt(0)
    s_barrier
    s_add_u32 m0, s71, 0
    s_nop 0
    buffer_load_dwordx4 v15, s[32:35], s62 offen offset:0 sc1 lds
    buffer_load_dwordx4 v15, s[32:35], s62 offen offset:1024 sc1 lds
    buffer_load_dwordx4 v15, s[32:35], s62 offen offset:2048 sc1 lds
    buffer_load_dwordx4 v15, s[32:35], s62 offen offset:3072 sc1 lds
    s_add_u32 s62, s62, 8192
    s_cmp_eq_u32 s62, s64
    s_cselect_b32 s62, s63, s62
    s_add_u32 s66, s75, 10
    s_sub_u32 s58, s66, 18
    s_cmp_ge_u32 s66, 18
    s_cselect_b32 s66, s58, s66
    s_mul_i32 s66, s66, 18432
    s_add_u32 s66, s66, s67
    s_add_u32 m0, s65, 83968
    s_nop 0
    buffer_load_dwordx4 v15, s[32:35], s66 offen offset:3072 sc1 lds
    s_add_u32 m0, m0, 4096
    s_mov_b32 exec_hi, 0
    buffer_load_dwordx4 v16, s[32:35], s66 offen sc1 lds
    s_mov_b32 exec_hi, -1
    s_add_u32 s66, s75, 11
    s_sub_u32 s58, s66, 18
    s_cmp_ge_u32 s66, 18
    s_cselect_b32 s66, s58, s66
    s_mul_i32 s66, s66, 18432
    s_add_u32 s66, s66, s67
    s_add_u32 m0, s65, 102400
    s_nop 0
    buffer_load_dwordx4 v15, s[32:35], s66 offen offset:0 sc1 lds
    buffer_load_dwordx4 v15, s[32:35], s66 offen offset:1024 sc1 lds
    buffer_load_dwordx4 v15, s[32:35], s66 offen offset:2048 sc1 lds
    s_waitcnt vmcnt(21) lgkmcnt(0)
    s_barrier
    s_add_u32 m0, s71, 16384
    s_nop 0
    buffer_load_dwordx4 v15, s[32:35], s62 offen offset:0 sc1 lds
    buffer_load_dwordx4 v15, s[32:35], s62 offen offset:1024 sc1 lds
    buffer_load_dwordx4 v15, s[32:35], s62 offen offset:2048 sc1 lds
    buffer_load_dwordx4 v15, s[32:35], s62 offen offset:3072 sc1 lds
    s_add_u32 s62, s62, 8192
    s_cmp_eq_u32 s62, s64
    s_cselect_b32 s62, s63, s62
    s_add_u32 s66, s75, 11
    s_sub_u32 s58, s66, 18
    s_cmp_ge_u32 s66, 18
    s_cselect_b32 s66, s58, s66
    s_mul_i32 s66, s66, 18432
    s_add_u32 s66, s66, s67
    s_add_u32 m0, s65, 102400
    s_nop 0
    buffer_load_dwordx4 v15, s[32:35], s66 offen offset:3072 sc1 lds
    s_add_u32 m0, m0, 4096
    s_mov_b32 exec_hi, 0
    buffer_load_dwordx4 v16, s[32:35], s66 offen sc1 lds
    s_mov_b32 exec_hi, -1
    s_waitcnt vmcnt(18) lgkmcnt(0)
    s_barrier
    s_add_u32 m0, s71, 32768
    s_nop 0
    buffer_load_dwordx4 v15, s[32:35], s62 offen offset:0 sc1 lds
    buffer_load_dwordx4 v15, s[32:35], s62 offen offset:1024 sc1 lds
    buffer_load_dwordx4 v15, s[32:35], s62 offen offset:2048 sc1 lds
    buffer_load_dwordx4 v15, s[32:35], s62 offen offset:3072 sc1 lds
    s_add_u32 s62, s62, 8192
    s_cmp_eq_u32 s62, s64
    s_cselect_b32 s62, s63, s62
    s_add_u32 s66, s75, 12
    s_sub_u32 s58, s66, 18
    s_cmp_ge_u32 s66, 18
    s_cselect_b32 s66, s58, s66
    s_mul_i32 s66, s66, 18432
    s_add_u32 s66, s66, s67
    s_add_u32 m0, s65, 120832
    s_nop 0
    buffer_load_dwordx4 v15, s[32:35], s66 offen offset:0 sc1 lds
    buffer_load_dwordx4 v15, s[32:35], s66 offen offset:1024 sc1 lds
    buffer_load_dwordx4 v15, s[32:35], s66 offen offset:2048 sc1 lds
    s_waitcnt vmcnt(16) lgkmcnt(0)
    s_barrier
    s_add_u32 m0, s71, 49152
    s_nop 0
    buffer_load_dwordx4 v15, s[32:35], s62 offen offset:0 sc1 lds
    buffer_load_dwordx4 v15, s[32:35], s62 offen offset:1024 sc1 lds
    buffer_load_dwordx4 v15, s[32:35], s62 offen offset:2048 sc1 lds
    buffer_load_dwordx4 v15, s[32:35], s62 offen offset:3072 sc1 lds
    s_add_u32 s62, s62, 8192
    s_cmp_eq_u32 s62, s64
    s_cselect_b32 s62, s63, s62
    s_add_u32 s66, s75, 12
    s_sub_u32 s58, s66, 18
    s_cmp_ge_u32 s66, 18
    s_cselect_b32 s66, s58, s66
    s_mul_i32 s66, s66, 18432
    s_add_u32 s66, s66, s67
    s_add_u32 m0, s65, 120832
    s_nop 0
    buffer_load_dwordx4 v15, s[32:35], s66 offen offset:3072 sc1 lds
    s_add_u32 m0, m0, 4096
    s_mov_b32 exec_hi, 0
    buffer_load_dwordx4 v16, s[32:35], s66 offen sc1 lds
    s_mov_b32 exec_hi, -1
    s_add_u32 s66, s75, 13
    s_sub_u32 s58, s66, 18
    s_cmp_ge_u32 s66, 18
    s_cselect_b32 s66, s58, s66
    s_mul_i32 s66, s66, 18432
    s_add_u32 s66, s66, s67
    s_add_u32 m0, s65, 139264
    s_nop 0
    buffer_load_dwordx4 v15, s[32:35], s66 offen offset:0 sc1 lds
    buffer_load_dwordx4 v15, s[32:35], s66 offen offset:1024 sc1 lds
    buffer_load_dwordx4 v15, s[32:35], s66 offen offset:2048 sc1 lds
    s_waitcnt vmcnt(18) lgkmcnt(0)
    s_barrier
    s_add_u32 m0, s71, 0
    s_nop 0
    buffer_load_dwordx4 v15, s[32:35], s62 offen offset:0 sc1 lds
    buffer_load_dwordx4 v15, s[32:35], s62 offen offset:1024 sc1 lds
    buffer_load_dwordx4 v15, s[32:35], s62 offen offset:2048 sc1 lds
    buffer_load_dwordx4 v15, s[32:35], s62 offen offset:3072 sc1 lds
    s_add_u32 s62, s62, 8192
    s_cmp_eq_u32 s62, s64
    s_cselect_b32 s62, s63, s62
    s_add_u32 s66, s75, 13
    s_sub_u32 s58, s66, 18
    s_cmp_ge_u32 s66, 18
    s_cselect_b32 s66, s58, s66
    s_mul_i32 s66, s66, 18432
    s_add_u32 s66, s66, s67
    s_add_u32 m0, s65, 139264
    s_nop 0
    buffer_load_dwordx4 v15, s[32:35], s66 offen offset:3072 sc1 lds
    s_add_u32 m0, m0, 4096
    s_mov_b32 exec_hi, 0
    buffer_load_dwordx4 v16, s[32:35], s66 offen sc1 lds
    s_mov_b32 exec_hi, -1
    s_waitcnt vmcnt(18) lgkmcnt(0)
    s_barrier
    s_add_u32 m0, s71, 16384
    s_nop 0
    buffer_load_dwordx4 v15, s[32:35], s62 offen offset:0 sc1 lds
    buffer_load_dwordx4 v15, s[32:35], s62 offen offset:1024 sc1 lds
    buffer_load_dwordx4 v15, s[32:35], s62 offen offset:2048 sc1 lds
    buffer_load_dwordx4 v15, s[32:35], s62 offen offset:3072 sc1 lds
    s_add_u32 s62, s62, 8192
    s_cmp_eq_u32 s62, s64
    s_cselect_b32 s62, s63, s62
    s_add_u32 s66, s75, 14
    s_sub_u32 s58, s66, 18
    s_cmp_ge_u32 s66, 18
    s_cselect_b32 s66, s58, s66
    s_mul_i32 s66, s66, 18432
    s_add_u32 s66, s66, s67
    s_add_u32 m0, s65, 65536
    s_nop 0
    buffer_load_dwordx4 v15, s[32:35], s66 offen offset:0 sc1 lds
    buffer_load_dwordx4 v15, s[32:35], s66 offen offset:1024 sc1 lds
    buffer_load_dwordx4 v15, s[32:35], s66 offen offset:2048 sc1 lds
    s_add_u32 s66, s75, 14
    s_sub_u32 s58, s66, 18
    s_cmp_ge_u32 s66, 18
    s_cselect_b32 s66, s58, s66
    s_mul_i32 s66, s66, 18432
    s_add_u32 s66, s66, s67
    s_add_u32 m0, s65, 65536
    s_nop 0
    buffer_load_dwordx4 v15, s[32:35], s66 offen offset:3072 sc1 lds
    s_add_u32 m0, m0, 4096
    s_mov_b32 exec_hi, 0
    buffer_load_dwordx4 v16, s[32:35], s66 offen sc1 lds
    s_mov_b32 exec_hi, -1
    s_waitcnt vmcnt(18) lgkmcnt(0)
    s_barrier
    s_add_u32 m0, s71, 32768
    s_nop 0
    buffer_load_dwordx4 v15, s[32:35], s62 offen offset:0 sc1 lds
    buffer_load_dwordx4 v15, s[32:35], s62 offen offset:1024 sc1 lds
    buffer_load_dwordx4 v15, s[32:35], s62 offen offset:2048 sc1 lds
    buffer_load_dwordx4 v15, s[32:35], s62 offen offset:3072 sc1 lds
    s_add_u32 s62, s62, 8192
    s_cmp_eq_u32 s62, s64
    s_cselect_b32 s62, s63, s62
    s_add_u32 s66, s75, 15
    s_sub_u32 s58, s66, 18
    s_cmp_ge_u32 s66, 18
    s_cselect_b32 s66, s58, s66
    s_mul_i32 s66, s66, 18432
    s_add_u32 s66, s66, s67
    s_add_u32 m0, s65, 83968
    s_nop 0
    buffer_load_dwordx4 v15, s[32:35], s66 offen offset:0 sc1 lds
    buffer_load_dwordx4 v15, s[32:35], s66 offen offset:1024 sc1 lds
    buffer_load_dwordx4 v15, s[32:35], s66 offen offset:2048 sc1 lds
    s_waitcnt vmcnt(18) lgkmcnt(0)
    s_barrier
    s_add_u32 m0, s71, 49152
    s_nop 0
    buffer_load_dwordx4 v15, s[32:35], s62 offen offset:0 sc1 lds
    buffer_load_dwordx4 v15, s[32:35], s62 offen offset:1024 sc1 lds
    buffer_load_dwordx4 v15, s[32:35], s62 offen offset:2048 sc1 lds
    buffer_load_dwordx4 v15, s[32:35], s62 offen offset:3072 sc1 lds
    s_add_u32 s62, s62, 8192
    s_cmp_eq_u32 s62, s64
    s_cselect_b32 s62, s63, s62
    s_add_u32 s66, s75, 15
    s_sub_u32 s58, s66, 18
    s_cmp_ge_u32 s66, 18
    s_cselect_b32 s66, s58, s66
    s_mul_i32 s66, s66, 18432
    s_add_u32 s66, s66, s67
    s_add_u32 m0, s65, 83968
    s_nop 0
    buffer_load_dwordx4 v15, s[32:35], s66 offen offset:3072 sc1 lds
    s_add_u32 m0, m0, 4096
    s_mov_b32 exec_hi, 0
    buffer_load_dwordx4 v16, s[32:35], s66 offen sc1 lds
    s_mov_b32 exec_hi, -1
    s_waitcnt vmcnt(18) lgkmcnt(0)
    s_barrier
    s_add_u32 m0, s71, 0
    s_nop 0
    buffer_load_dwordx4 v15, s[32:35], s62 offen offset:0 sc1 lds
    buffer_load_dwordx4 v15, s[32:35], s62 offen offset:1024 sc1 lds
    buffer_load_dwordx4 v15, s[32:35], s62 offen offset:2048 sc1 lds
    buffer_load_dwordx4 v15, s[32:35], s62 offen offset:3072 sc1 lds
    s_add_u32 s62, s62, 8192
    s_cmp_eq_u32 s62, s64
    s_cselect_b32 s62, s63, s62
    s_add_u32 s66, s75, 16
    s_sub_u32 s58, s66, 18
    s_cmp_ge_u32 s66, 18
    s_cselect_b32 s66, s58, s66
    s_mul_i32 s66, s66, 18432
    s_add_u32 s66, s66, s67
    s_add_u32 m0, s65, 102400
    s_nop 0
    buffer_load_dwordx4 v15, s[32:35], s66 offen offset:0 sc1 lds
    buffer_load_dwordx4 v15, s[32:35], s66 offen offset:1024 sc1 lds
    buffer_load_dwordx4 v15, s[32:35], s66 offen offset:2048 sc1 lds
    s_add_u32 s66, s75, 16
    s_sub_u32 s58, s66, 18
    s_cmp_ge_u32 s66, 18
    s_cselect_b32 s66, s58, s66
    s_mul_i32 s66, s66, 18432
    s_add_u32 s66, s66, s67
    s_add_u32 m0, s65, 102400
    s_nop 0
    buffer_load_dwordx4 v15, s[32:35], s66 offen offset:3072 sc1 lds
    s_add_u32 m0, m0, 4096
    s_mov_b32 exec_hi, 0
    buffer_load_dwordx4 v16, s[32:35], s66 offen sc1 lds
    s_mov_b32 exec_hi, -1
    s_waitcnt vmcnt(18) lgkmcnt(0)
    s_barrier
    s_add_u32 m0, s71, 16384
    s_nop 0
    buffer_load_dwordx4 v15, s[32:35], s62 offen offset:0 sc1 lds
    buffer_load_dwordx4 v15, s[32:35], s62 offen offset:1024 sc1 lds
    buffer_load_dwordx4 v15, s[32:35], s62 offen offset:2048 sc1 lds
    buffer_load_dwordx4 v15, s[32:35], s62 offen offset:3072 sc1 lds
    s_add_u32 s62, s62, 8192
    s_cmp_eq_u32 s62, s64
    s_cselect_b32 s62, s63, s62
    s_add_u32 s66, s75, 17
    s_sub_u32 s58, s66, 18
    s_cmp_ge_u32 s66, 18
    s_cselect_b32 s66, s58, s66
    s_mul_i32 s66, s66, 18432
    s_add_u32 s66, s66, s67
    s_add_u32 m0, s65, 120832
    s_nop 0
    buffer_load_dwordx4 v15, s[32:35], s66 offen offset:0 sc1 lds
    buffer_load_dwordx4 v15, s[32:35], s66 offen offset:1024 sc1 lds
    buffer_load_dwordx4 v15, s[32:35], s66 offen offset:2048 sc1 lds
    s_waitcnt vmcnt(16) lgkmcnt(0)
    s_barrier
    s_add_u32 s66, s75, 17
    s_sub_u32 s58, s66, 18
    s_cmp_ge_u32 s66, 18
    s_cselect_b32 s66, s58, s66
    s_mul_i32 s66, s66, 18432
    s_add_u32 s66, s66, s67
    s_add_u32 m0, s65, 120832
    s_nop 0
    buffer_load_dwordx4 v15, s[32:35], s66 offen offset:3072 sc1 lds
    s_add_u32 m0, m0, 4096
    s_mov_b32 exec_hi, 0
    buffer_load_dwordx4 v16, s[32:35], s66 offen sc1 lds
    s_mov_b32 exec_hi, -1
    s_waitcnt vmcnt(9) lgkmcnt(0)
    s_barrier
    s_waitcnt vmcnt(0) lgkmcnt(0)
    s_barrier
    s_endpgm
L_consumer:
    s_sub_u32 s56, s52, 4
    s_lshr_b32 s58, s2, 3
    s_lshl_b32 s59, s56, 5
    s_add_u32 s58, s58, s59
    s_getpc_b64 s[78:79]
L_pc_a:
    s_lshl_b32 s57, s58, 12
    v_lshlrev_b32 v5, 6, v0
    v_add_u32 v5, s57, v5
    s_add_u32 s78, s78, standalone__mixer_gmlp__prompt_kernel-L_pc_a
    s_addc_u32 s79, s79, -1
    v_cmp_gt_u32 vcc, L_end-standalone__mixer_gmlp__prompt_kernel, v5
    s_and_saveexec_b64 s[76:77], vcc
    s_cbranch_execz L_pcs_a
    global_load_dword v6, v5, s[78:79]
L_pcs_a:
    s_mov_b64 exec, -1
    v_lshlrev_b32 v1, 4, v0
    s_waitcnt lgkmcnt(0)
    s_mov_b32 s32, s18
    s_mov_b32 s33, s19
    s_mov_b32 s34, 24117248
    s_mov_b32 s35, 0x20000
    s_mov_b32 s40, s16
    s_mov_b32 s41, s17
    s_mov_b32 s42, 256
    s_mov_b32 s43, 0x20000
    s_mov_b32 s44, s12
    s_mov_b32 s45, s13
    s_mov_b32 s46, 2654208
    s_mov_b32 s47, 0x20000
    s_mov_b32 s48, s10
    s_mov_b32 s49, s11
    s_mov_b32 s50, 4096
    s_mov_b32 s51, 0x20000
    s_mov_b32 s36, s14
    s_mov_b32 s37, s15
    s_mov_b32 s38, 2359296
    s_mov_b32 s39, 0x20000
    s_mov_b32 s28, s8
    s_mov_b32 s29, s9
    s_mov_b32 s30, 8388608
    s_mov_b32 s31, 0x20000
    s_or_b32 s57, s2, s56
    s_cmp_lg_u32 s57, 0
    s_cbranch_scc1 L_nononce
    s_memrealtime s[78:79]
    s_waitcnt lgkmcnt(0)
    s_or_b32 s57, s78, 1
    v_mov_b32 v246, s57
    v_mov_b32 v247, 0
    s_mov_b64 exec, 1
    buffer_store_dword v246, v247, s[40:43], 0 offen sc1
    s_mov_b64 exec, -1
L_nononce:
    v_bfe_u32 v246, v0, 2, 2
    v_lshlrev_b32 v246, 3, v246
    v_and_b32 v247, 3, v0
    v_add_u32 v246, v246, v247
    s_lshl_b32 s57, s53, 7
    s_lshl_b32 s58, s56, 5
    s_add_u32 s57, s57, s58
    v_add_lshl_u32 v246, v246, s57, 1
    v_mov_b32 v7, v246
    v_and_b32 v246, 15, v0
    v_lshrrev_b32 v247, 4, v0
    v_bfe_u32 v248, v0, 1, 3
    v_xor_b32 v248, v247, v248
    v_lshlrev_b32 v248, 4, v248
    v_lshl_add_u32 v236, v246, 7, v248
    s_lshl_b32 s57, s56, 12
    v_add_u32 v236, s57, v236
    v_xor_b32 v237, 64, v236
    v_add_u32 v238, 16384, v1
    v_lshrrev_b32 v246, 5, v0
    v_lshlrev_b32 v246, 4, v246
    v_bfe_u32 v247, v0, 2, 3
    v_add_u32 v246, v246, v247
    v_mul_u32_u24 v246, 288, v246
    v_and_b32 v247, 3, v0
    v_lshl_add_u32 v239, v247, 3, v246
    v_add_u32 v239, 16384, v239
    v_mov_b32 v240, 0xc0135761
    v_mov_b32 v242, 0xbdd2d3e8
    v_mov_b32 v244, 1.0
    v_mov_b32 v241, 0xc0135761
    v_mov_b32 v243, 0xbdd2d3e8
    v_mov_b32 v245, 1.0
    s_mov_b32 s61, 0
    s_mov_b32 s65, 4294862848
    v_mov_b32 v8, 0
    v_mov_b32 v9, 0
    v_mov_b32 v10, 0
    v_mov_b32 v11, 0
    v_mov_b32 v12, 0
    v_mov_b32 v13, 0
    v_mov_b32 v14, 0
    v_mov_b32 v15, 0
    v_mov_b32 v16, 0
    v_mov_b32 v17, 0
    v_mov_b32 v18, 0
    v_mov_b32 v19, 0
    v_mov_b32 v20, 0
    v_mov_b32 v21, 0
    v_mov_b32 v22, 0
    v_mov_b32 v23, 0
    v_mov_b32 v24, 0
    v_mov_b32 v25, 0
    v_mov_b32 v26, 0
    v_mov_b32 v27, 0
    v_mov_b32 v28, 0
    v_mov_b32 v29, 0
    v_mov_b32 v30, 0
    v_mov_b32 v31, 0
    v_mov_b32 v32, 0
    v_mov_b32 v33, 0
    v_mov_b32 v34, 0
    v_mov_b32 v35, 0
    v_mov_b32 v36, 0
    v_mov_b32 v37, 0
    v_mov_b32 v38, 0
    v_mov_b32 v39, 0
    v_mov_b32 v40, 0
    v_mov_b32 v41, 0
    v_mov_b32 v42, 0
    v_mov_b32 v43, 0
    v_mov_b32 v44, 0
    v_mov_b32 v45, 0
    v_mov_b32 v46, 0
    v_mov_b32 v47, 0
    v_mov_b32 v48, 0
    v_mov_b32 v49, 0
    v_mov_b32 v50, 0
    v_mov_b32 v51, 0
    v_mov_b32 v52, 0
    v_mov_b32 v53, 0
    v_mov_b32 v54, 0
    v_mov_b32 v55, 0
    v_mov_b32 v56, 0
    v_mov_b32 v57, 0
    v_mov_b32 v58, 0
    v_mov_b32 v59, 0
    v_mov_b32 v60, 0
    v_mov_b32 v61, 0
    v_mov_b32 v62, 0
    v_mov_b32 v63, 0
    v_mov_b32 v64, 0
    v_mov_b32 v65, 0
    v_mov_b32 v66, 0
    v_mov_b32 v67, 0
    v_mov_b32 v68, 0
    v_mov_b32 v69, 0
    v_mov_b32 v70, 0
    v_mov_b32 v71, 0
    v_mov_b32 v72, 0
    v_mov_b32 v73, 0
    v_mov_b32 v74, 0
    v_mov_b32 v75, 0
    v_mov_b32 v76, 0
    v_mov_b32 v77, 0
    v_mov_b32 v78, 0
    v_mov_b32 v79, 0
    v_mov_b32 v80, 0
    v_mov_b32 v81, 0
    v_mov_b32 v82, 0
    v_mov_b32 v83, 0
    v_mov_b32 v84, 0
    v_mov_b32 v85, 0
    v_mov_b32 v86, 0
    v_mov_b32 v87, 0
    v_mov_b32 v88, 0
    v_mov_b32 v89, 0
    v_mov_b32 v90, 0
    v_mov_b32 v91, 0
    v_mov_b32 v92, 0
    v_mov_b32 v93, 0
    v_mov_b32 v94, 0
    v_mov_b32 v95, 0
    v_mov_b32 v96, 0
    v_mov_b32 v97, 0
    v_mov_b32 v98, 0
    v_mov_b32 v99, 0
    v_mov_b32 v100, 0
    v_mov_b32 v101, 0
    v_mov_b32 v102, 0
    v_mov_b32 v103, 0
    v_mov_b32 v104, 0
    v_mov_b32 v105, 0
    v_mov_b32 v106, 0
    v_mov_b32 v107, 0
    v_mov_b32 v108, 0
    v_mov_b32 v109, 0
    v_mov_b32 v110, 0
    v_mov_b32 v111, 0
    v_mov_b32 v112, 0
    v_mov_b32 v113, 0
    v_mov_b32 v114, 0
    v_mov_b32 v115, 0
    v_mov_b32 v116, 0
    v_mov_b32 v117, 0
    v_mov_b32 v118, 0
    v_mov_b32 v119, 0
    v_mov_b32 v120, 0
    v_mov_b32 v121, 0
    v_mov_b32 v122, 0
    v_mov_b32 v123, 0
    v_mov_b32 v124, 0
    v_mov_b32 v125, 0
    v_mov_b32 v126, 0
    v_mov_b32 v127, 0
    v_mov_b32 v128, 0
    v_mov_b32 v129, 0
    v_mov_b32 v130, 0
    v_mov_b32 v131, 0
    v_mov_b32 v132, 0
    v_mov_b32 v133, 0
    v_mov_b32 v134, 0
    v_mov_b32 v135, 0
    v_mov_b32 v136, 0
    v_mov_b32 v137, 0
    v_mov_b32 v138, 0
    v_mov_b32 v139, 0
    v_mov_b32 v140, 0
    v_mov_b32 v141, 0
    v_mov_b32 v142, 0
    v_mov_b32 v143, 0
    v_mov_b32 v144, 0
    v_mov_b32 v145, 0
    v_mov_b32 v146, 0
    v_mov_b32 v147, 0
    v_mov_b32 v148, 0
    v_mov_b32 v149, 0
    v_mov_b32 v150, 0
    v_mov_b32 v151, 0
    s_mov_b32 s69, 9
    s_mov_b32 s24, s6
    s_mov_b32 s25, s7
    s_mov_b32 s26, 5308416
    s_mov_b32 s27, 0x20000
    s_mul_i32 s57, s56, 192
    v_add_u32 v246, s57, v0
    v_min_u32 v246, 647, v246
    v_mul_u32_u24 v247, 58255, v246
    v_lshrrev_b32 v247, 22, v247
    v_mul_u32_u24 v248, 72, v247
    v_sub_u32 v246, v246, v248
    v_mul_u32_u24 v247, 9216, v247
    v_lshl_add_u32 v204, v246, 4, v247
    v_add_u32 v246, s57, v0
    v_add_u32 v246, 64, v246
    v_min_u32 v246, 647, v246
    v_mul_u32_u24 v247, 58255, v246
    v_lshrrev_b32 v247, 22, v247
    v_mul_u32_u24 v248, 72, v247
    v_sub_u32 v246, v246, v248
    v_mul_u32_u24 v247, 9216, v247
    v_lshl_add_u32 v205, v246, 4, v247
    v_add_u32 v246, s57, v0
    v_add_u32 v246, 128, v246
    v_min_u32 v246, 647, v246
    v_mul_u32_u24 v247, 58255, v246
    v_lshrrev_b32 v247, 22, v247
    v_mul_u32_u24 v248, 72, v247
    v_sub_u32 v246, v246, v248
    v_mul_u32_u24 v247, 9216, v247
    v_lshl_add_u32 v206, v246, 4, v247
    s_and_b32 s57, s55, 1
    s_lshl_b32 s57, s57, 5
    s_lshr_b32 s58, s2, 3
    s_add_u32 s57, s57, s58
    s_mul_i32 s68, s57, 82944
    s_lshr_b32 s58, s55, 1
    s_mul_i32 s58, s58, 1152
    s_add_u32 s68, s68, s58
    v_mov_b32 v207, v1
    v_mov_b32 v4, v1
    s_lshl_b32 s71, s53, 19
    s_lshl_b32 s58, s54, 15
    s_add_u32 s71, s71, s58
    s_lshl_b32 s58, s56, 13
    s_add_u32 s71, s71, s58
    v_mov_b32 v246, 0
    s_mov_b32 m0, 159744
    s_barrier
    ds_read_b128 v[152:155], v236 offset:0
    ds_read_b128 v[156:159], v236 offset:2048
    ds_read_b64_tr_b16 v[168:169], v239 offset:0
    ds_read_b64_tr_b16 v[170:171], v239 offset:2304
    ds_read_b64_tr_b16 v[172:173], v239 offset:32
    ds_read_b64_tr_b16 v[174:175], v239 offset:2336
    ds_read_b64_tr_b16 v[176:177], v239 offset:64
    ds_read_b64_tr_b16 v[178:179], v239 offset:2368
    ds_read_b64_tr_b16 v[180:181], v239 offset:96
    ds_read_b64_tr_b16 v[182:183], v239 offset:2400
    ds_read_b64_tr_b16 v[184:185], v239 offset:128
    ds_read_b64_tr_b16 v[186:187], v239 offset:2432
    ds_read_b64_tr_b16 v[188:189], v239 offset:160
    ds_read_b64_tr_b16 v[190:191], v239 offset:2464
    ds_read_b64_tr_b16 v[192:193], v239 offset:192
    ds_read_b64_tr_b16 v[194:195], v239 offset:2496
    ds_read_b64_tr_b16 v[196:197], v239 offset:224
    ds_read_b64_tr_b16 v[198:199], v239 offset:2528
    ds_read_b64_tr_b16 v[200:201], v239 offset:256
    ds_read_b64_tr_b16 v[202:203], v239 offset:2560
L_cA:
    s_waitcnt lgkmcnt(14)
    v_mfma_f32_16x16x32_bf16 v[8:11], v[152:155], v[168:171], v[8:11]
    ds_read_b128 v[160:163], v237 offset:0
    ds_read_b128 v[164:167], v237 offset:2048
    v_mfma_f32_16x16x32_bf16 v[12:15], v[156:159], v[168:171], v[12:15]
    ds_read_b64_tr_b16 v[168:169], v239 offset:9216
    v_mfma_f32_16x16x32_bf16 v[16:19], v[152:155], v[172:175], v[16:19]
    ds_read_b64_tr_b16 v[170:171], v239 offset:11520
    v_mfma_f32_16x16x32_bf16 v[20:23], v[156:159], v[172:175], v[20:23]
    ds_read_b64_tr_b16 v[172:173], v239 offset:9248
    s_waitcnt lgkmcnt(14)
    v_mfma_f32_16x16x32_bf16 v[24:27], v[152:155], v[176:179], v[24:27]
    ds_read_b64_tr_b16 v[174:175], v239 offset:11552
    v_mfma_f32_16x16x32_bf16 v[28:31], v[156:159], v[176:179], v[28:31]
    ds_read_b64_tr_b16 v[176:177], v239 offset:9280
    v_mfma_f32_16x16x32_bf16 v[32:35], v[152:155], v[180:183], v[32:35]
    ds_read_b64_tr_b16 v[178:179], v239 offset:11584
    v_mfma_f32_16x16x32_bf16 v[36:39], v[156:159], v[180:183], v[36:39]
    ds_read_b64_tr_b16 v[180:181], v239 offset:9312
    s_waitcnt lgkmcnt(14)
    v_mfma_f32_16x16x32_bf16 v[40:43], v[152:155], v[184:187], v[40:43]
    ds_read_b64_tr_b16 v[182:183], v239 offset:11616
    v_mfma_f32_16x16x32_bf16 v[44:47], v[156:159], v[184:187], v[44:47]
    ds_read_b64_tr_b16 v[184:185], v239 offset:9344
    v_mfma_f32_16x16x32_bf16 v[48:51], v[152:155], v[188:191], v[48:51]
    ds_read_b64_tr_b16 v[186:187], v239 offset:11648
    v_mfma_f32_16x16x32_bf16 v[52:55], v[156:159], v[188:191], v[52:55]
    ds_read_b64_tr_b16 v[188:189], v239 offset:9376
    s_waitcnt lgkmcnt(14)
    v_mfma_f32_16x16x32_bf16 v[56:59], v[152:155], v[192:195], v[56:59]
    ds_read_b64_tr_b16 v[190:191], v239 offset:11680
    v_mfma_f32_16x16x32_bf16 v[60:63], v[156:159], v[192:195], v[60:63]
    ds_read_b64_tr_b16 v[192:193], v239 offset:9408
    v_mfma_f32_16x16x32_bf16 v[64:67], v[152:155], v[196:199], v[64:67]
    ds_read_b64_tr_b16 v[194:195], v239 offset:11712
    v_mfma_f32_16x16x32_bf16 v[68:71], v[156:159], v[196:199], v[68:71]
    ds_read_b64_tr_b16 v[196:197], v239 offset:9440
    s_waitcnt lgkmcnt(14)
    v_mfma_f32_16x16x32_bf16 v[72:75], v[152:155], v[200:203], v[72:75]
    ds_read_b64_tr_b16 v[198:199], v239 offset:11744
    v_mfma_f32_16x16x32_bf16 v[76:79], v[156:159], v[200:203], v[76:79]
    ds_read_b64_tr_b16 v[200:201], v239 offset:9472
    ds_read_b64_tr_b16 v[202:203], v239 offset:11776
    s_waitcnt lgkmcnt(14)
    v_mfma_f32_16x16x32_bf16 v[8:11], v[160:163], v[168:171], v[8:11]
    s_add_u32 s61, s61, 1
    s_and_b32 s61, s61, 3
    s_cselect_b32 s62, 34816, s65
    v_mfma_f32_16x16x32_bf16 v[12:15], v[164:167], v[168:171], v[12:15]
    v_add_u32 v236, s62, v236
    v_mfma_f32_16x16x32_bf16 v[16:19], v[160:163], v[172:175], v[16:19]
    v_add_u32 v237, s62, v237
    v_mfma_f32_16x16x32_bf16 v[20:23], v[164:167], v[172:175], v[20:23]
    v_add_u32 v238, s62, v238
    s_waitcnt lgkmcnt(12)
    v_mfma_f32_16x16x32_bf16 v[24:27], v[160:163], v[176:179], v[24:27]
    v_add_u32 v239, s62, v239
    v_mfma_f32_16x16x32_bf16 v[28:31], v[164:167], v[176:179], v[28:31]
    s_cmp_lg_u32 s69, 3
    s_cbranch_scc1 L_pf_done
    s_mov_b32 m0, 159744
    buffer_load_ushort v2, v7, s[48:51], 0 offen
    buffer_load_ushort v3, v7, s[48:51], 0 offen offset:8
    buffer_load_dword v247, v246, s[40:43], 0 offen sc1
    buffer_load_dwordx4 v204, s[24:27], s68 offen lds
    buffer_load_dwordx4 v205, s[24:27], s68 offen lds
    buffer_load_dwordx4 v206, s[24:27], s68 offen lds
L_pf_done:
    s_waitcnt lgkmcnt(0)
    s_barrier
    v_mfma_f32_16x16x32_bf16 v[32:35], v[160:163], v[180:183], v[32:35]
    ds_read_b128 v[152:155], v236 offset:0
    ds_read_b128 v[156:159], v236 offset:2048
    v_mfma_f32_16x16x32_bf16 v[36:39], v[164:167], v[180:183], v[36:39]
    ds_read_b64_tr_b16 v[168:169], v239 offset:0
    ds_read_b64_tr_b16 v[170:171], v239 offset:2304
    v_mfma_f32_16x16x32_bf16 v[40:43], v[160:163], v[184:187], v[40:43]
    ds_read_b64_tr_b16 v[172:173], v239 offset:32
    ds_read_b64_tr_b16 v[174:175], v239 offset:2336
    v_mfma_f32_16x16x32_bf16 v[44:47], v[164:167], v[184:187], v[44:47]
    ds_read_b64_tr_b16 v[176:177], v239 offset:64
    ds_read_b64_tr_b16 v[178:179], v239 offset:2368
    v_mfma_f32_16x16x32_bf16 v[48:51], v[160:163], v[188:191], v[48:51]
    ds_read_b64_tr_b16 v[180:181], v239 offset:96
    ds_read_b64_tr_b16 v[182:183], v239 offset:2400
    v_mfma_f32_16x16x32_bf16 v[52:55], v[164:167], v[188:191], v[52:55]
    ds_read_b64_tr_b16 v[184:185], v239 offset:128
    ds_read_b64_tr_b16 v[186:187], v239 offset:2432
    v_mfma_f32_16x16x32_bf16 v[56:59], v[160:163], v[192:195], v[56:59]
    ds_read_b64_tr_b16 v[188:189], v239 offset:160
    ds_read_b64_tr_b16 v[190:191], v239 offset:2464
    v_mfma_f32_16x16x32_bf16 v[60:63], v[164:167], v[192:195], v[60:63]
    ds_read_b64_tr_b16 v[192:193], v239 offset:192
    v_mfma_f32_16x16x32_bf16 v[64:67], v[160:163], v[196:199], v[64:67]
    ds_read_b64_tr_b16 v[194:195], v239 offset:2496
    v_mfma_f32_16x16x32_bf16 v[68:71], v[164:167], v[196:199], v[68:71]
    ds_read_b64_tr_b16 v[196:197], v239 offset:224
    v_mfma_f32_16x16x32_bf16 v[72:75], v[160:163], v[200:203], v[72:75]
    ds_read_b64_tr_b16 v[198:199], v239 offset:2528
    v_mfma_f32_16x16x32_bf16 v[76:79], v[164:167], v[200:203], v[76:79]
    ds_read_b64_tr_b16 v[200:201], v239 offset:256
    ds_read_b64_tr_b16 v[202:203], v239 offset:2560
    s_sub_u32 s69, s69, 1
    s_cmp_lg_u32 s69, 0
    s_cbranch_scc1 L_cA
    s_nop 7
    v_pk_mul_f32 v[204:205], v[8:9], v[8:9]
    v_pk_mul_f32 v[206:207], v[10:11], v[10:11]
    v_pk_mul_f32 v[208:209], v[12:13], v[12:13]
    v_pk_mul_f32 v[210:211], v[14:15], v[14:15]
    v_pk_fma_f32 v[204:205], v[204:205], v[242:243], v[240:241]
    v_pk_fma_f32 v[206:207], v[206:207], v[242:243], v[240:241]
    v_pk_fma_f32 v[208:209], v[208:209], v[242:243], v[240:241]
    v_pk_fma_f32 v[210:211], v[210:211], v[242:243], v[240:241]
    v_pk_mul_f32 v[204:205], v[204:205], v[8:9]
    v_pk_mul_f32 v[206:207], v[206:207], v[10:11]
    v_pk_mul_f32 v[208:209], v[208:209], v[12:13]
    v_pk_mul_f32 v[210:211], v[210:211], v[14:15]
    v_exp_f32 v204, v204
    v_exp_f32 v205, v205
    v_exp_f32 v206, v206
    v_exp_f32 v207, v207
    v_exp_f32 v208, v208
    v_exp_f32 v209, v209
    v_exp_f32 v210, v210
    v_exp_f32 v211, v211
    v_pk_add_f32 v[204:205], v[204:205], v[244:245]
    v_pk_add_f32 v[206:207], v[206:207], v[244:245]
    v_pk_add_f32 v[208:209], v[208:209], v[244:245]
    v_pk_add_f32 v[210:211], v[210:211], v[244:245]
    v_rcp_f32 v204, v204
    v_rcp_f32 v205, v205
    v_rcp_f32 v206, v206
    v_rcp_f32 v207, v207
    v_rcp_f32 v208, v208
    v_rcp_f32 v209, v209
    v_rcp_f32 v210, v210
    v_rcp_f32 v211, v211
    v_pk_mul_f32 v[8:9], v[8:9], v[204:205]
    v_pk_mul_f32 v[10:11], v[10:11], v[206:207]
    v_pk_mul_f32 v[12:13], v[12:13], v[208:209]
    v_pk_mul_f32 v[14:15], v[14:15], v[210:211]
    v_pk_mul_f32 v[204:205], v[16:17], v[16:17]
    v_pk_mul_f32 v[206:207], v[18:19], v[18:19]
    v_pk_mul_f32 v[208:209], v[20:21], v[20:21]
    v_pk_mul_f32 v[210:211], v[22:23], v[22:23]
    v_pk_fma_f32 v[204:205], v[204:205], v[242:243], v[240:241]
    v_pk_fma_f32 v[206:207], v[206:207], v[242:243], v[240:241]
    v_pk_fma_f32 v[208:209], v[208:209], v[242:243], v[240:241]
    v_pk_fma_f32 v[210:211], v[210:211], v[242:243], v[240:241]
    v_pk_mul_f32 v[204:205], v[204:205], v[16:17]
    v_pk_mul_f32 v[206:207], v[206:207], v[18:19]
    v_pk_mul_f32 v[208:209], v[208:209], v[20:21]
    v_pk_mul_f32 v[210:211], v[210:211], v[22:23]
    v_exp_f32 v204, v204
    v_exp_f32 v205, v205
    v_exp_f32 v206, v206
    v_exp_f32 v207, v207
    v_exp_f32 v208, v208
    v_exp_f32 v209, v209
    v_exp_f32 v210, v210
    v_exp_f32 v211, v211
    v_pk_add_f32 v[204:205], v[204:205], v[244:245]
    v_pk_add_f32 v[206:207], v[206:207], v[244:245]
    v_pk_add_f32 v[208:209], v[208:209], v[244:245]
    v_pk_add_f32 v[210:211], v[210:211], v[244:245]
    v_rcp_f32 v204, v204
    v_rcp_f32 v205, v205
    v_rcp_f32 v206, v206
    v_rcp_f32 v207, v207
    v_rcp_f32 v208, v208
    v_rcp_f32 v209, v209
    v_rcp_f32 v210, v210
    v_rcp_f32 v211, v211
    v_pk_mul_f32 v[16:17], v[16:17], v[204:205]
    v_pk_mul_f32 v[18:19], v[18:19], v[206:207]
    v_pk_mul_f32 v[20:21], v[20:21], v[208:209]
    v_pk_mul_f32 v[22:23], v[22:23], v[210:211]
    v_pk_mul_f32 v[204:205], v[24:25], v[24:25]
    v_pk_mul_f32 v[206:207], v[26:27], v[26:27]
    v_pk_mul_f32 v[208:209], v[28:29], v[28:29]
    v_pk_mul_f32 v[210:211], v[30:31], v[30:31]
    v_pk_fma_f32 v[204:205], v[204:205], v[242:243], v[240:241]
    v_pk_fma_f32 v[206:207], v[206:207], v[242:243], v[240:241]
    v_pk_fma_f32 v[208:209], v[208:209], v[242:243], v[240:241]
    v_pk_fma_f32 v[210:211], v[210:211], v[242:243], v[240:241]
    v_pk_mul_f32 v[204:205], v[204:205], v[24:25]
    v_pk_mul_f32 v[206:207], v[206:207], v[26:27]
    v_pk_mul_f32 v[208:209], v[208:209], v[28:29]
    v_pk_mul_f32 v[210:211], v[210:211], v[30:31]
    v_exp_f32 v204, v204
    v_exp_f32 v205, v205
    v_exp_f32 v206, v206
    v_exp_f32 v207, v207
    v_exp_f32 v208, v208
    v_exp_f32 v209, v209
    v_exp_f32 v210, v210
    v_exp_f32 v211, v211
    v_pk_add_f32 v[204:205], v[204:205], v[244:245]
    v_pk_add_f32 v[206:207], v[206:207], v[244:245]
    v_pk_add_f32 v[208:209], v[208:209], v[244:245]
    v_pk_add_f32 v[210:211], v[210:211], v[244:245]
    v_rcp_f32 v204, v204
    v_rcp_f32 v205, v205
    v_rcp_f32 v206, v206
    v_rcp_f32 v207, v207
    v_rcp_f32 v208, v208
    v_rcp_f32 v209, v209
    v_rcp_f32 v210, v210
    v_rcp_f32 v211, v211
    v_pk_mul_f32 v[24:25], v[24:25], v[204:205]
    v_pk_mul_f32 v[26:27], v[26:27], v[206:207]
    v_pk_mul_f32 v[28:29], v[28:29], v[208:209]
    v_pk_mul_f32 v[30:31], v[30:31], v[210:211]
    v_pk_mul_f32 v[204:205], v[32:33], v[32:33]
    v_pk_mul_f32 v[206:207], v[34:35], v[34:35]
    v_pk_mul_f32 v[208:209], v[36:37], v[36:37]
    v_pk_mul_f32 v[210:211], v[38:39], v[38:39]
    v_pk_fma_f32 v[204:205], v[204:205], v[242:243], v[240:241]
    v_pk_fma_f32 v[206:207], v[206:207], v[242:243], v[240:241]
    v_pk_fma_f32 v[208:209], v[208:209], v[242:243], v[240:241]
    v_pk_fma_f32 v[210:211], v[210:211], v[242:243], v[240:241]
    v_pk_mul_f32 v[204:205], v[204:205], v[32:33]
    v_pk_mul_f32 v[206:207], v[206:207], v[34:35]
    v_pk_mul_f32 v[208:209], v[208:209], v[36:37]
    v_pk_mul_f32 v[210:211], v[210:211], v[38:39]
    v_exp_f32 v204, v204
    v_exp_f32 v205, v205
    v_exp_f32 v206, v206
    v_exp_f32 v207, v207
    v_exp_f32 v208, v208
    v_exp_f32 v209, v209
    v_exp_f32 v210, v210
    v_exp_f32 v211, v211
    v_pk_add_f32 v[204:205], v[204:205], v[244:245]
    v_pk_add_f32 v[206:207], v[206:207], v[244:245]
    v_pk_add_f32 v[208:209], v[208:209], v[244:245]
    v_pk_add_f32 v[210:211], v[210:211], v[244:245]
    v_rcp_f32 v204, v204
    v_rcp_f32 v205, v205
    v_rcp_f32 v206, v206
    v_rcp_f32 v207, v207
    v_rcp_f32 v208, v208
    v_rcp_f32 v209, v209
    v_rcp_f32 v210, v210
    v_rcp_f32 v211, v211
    v_pk_mul_f32 v[32:33], v[32:33], v[204:205]
    v_pk_mul_f32 v[34:35], v[34:35], v[206:207]
    v_pk_mul_f32 v[36:37], v[36:37], v[208:209]
    v_pk_mul_f32 v[38:39], v[38:39], v[210:211]
    v_pk_mul_f32 v[204:205], v[40:41], v[40:41]
    v_pk_mul_f32 v[206:207], v[42:43], v[42:43]
    v_pk_mul_f32 v[208:209], v[44:45], v[44:45]
    v_pk_mul_f32 v[210:211], v[46:47], v[46:47]
    v_pk_fma_f32 v[204:205], v[204:205], v[242:243], v[240:241]
    v_pk_fma_f32 v[206:207], v[206:207], v[242:243], v[240:241]
    v_pk_fma_f32 v[208:209], v[208:209], v[242:243], v[240:241]
    v_pk_fma_f32 v[210:211], v[210:211], v[242:243], v[240:241]
    v_pk_mul_f32 v[204:205], v[204:205], v[40:41]
    v_pk_mul_f32 v[206:207], v[206:207], v[42:43]
    v_pk_mul_f32 v[208:209], v[208:209], v[44:45]
    v_pk_mul_f32 v[210:211], v[210:211], v[46:47]
    v_exp_f32 v204, v204
    v_exp_f32 v205, v205
    v_exp_f32 v206, v206
    v_exp_f32 v207, v207
    v_exp_f32 v208, v208
    v_exp_f32 v209, v209
    v_exp_f32 v210, v210
    v_exp_f32 v211, v211
    v_pk_add_f32 v[204:205], v[204:205], v[244:245]
    v_pk_add_f32 v[206:207], v[206:207], v[244:245]
    v_pk_add_f32 v[208:209], v[208:209], v[244:245]
    v_pk_add_f32 v[210:211], v[210:211], v[244:245]
    v_rcp_f32 v204, v204
    v_rcp_f32 v205, v205
    v_rcp_f32 v206, v206
    v_rcp_f32 v207, v207
    v_rcp_f32 v208, v208
    v_rcp_f32 v209, v209
    v_rcp_f32 v210, v210
    v_rcp_f32 v211, v211
    v_pk_mul_f32 v[40:41], v[40:41], v[204:205]
    v_pk_mul_f32 v[42:43], v[42:43], v[206:207]
    v_pk_mul_f32 v[44:45], v[44:45], v[208:209]
    v_pk_mul_f32 v[46:47], v[46:47], v[210:211]
    v_pk_mul_f32 v[204:205], v[48:49], v[48:49]
    v_pk_mul_f32 v[206:207], v[50:51], v[50:51]
    v_pk_mul_f32 v[208:209], v[52:53], v[52:53]
    v_pk_mul_f32 v[210:211], v[54:55], v[54:55]
    v_pk_fma_f32 v[204:205], v[204:205], v[242:243], v[240:241]
    v_pk_fma_f32 v[206:207], v[206:207], v[242:243], v[240:241]
    v_pk_fma_f32 v[208:209], v[208:209], v[242:243], v[240:241]
    v_pk_fma_f32 v[210:211], v[210:211], v[242:243], v[240:241]
    v_pk_mul_f32 v[204:205], v[204:205], v[48:49]
    v_pk_mul_f32 v[206:207], v[206:207], v[50:51]
    v_pk_mul_f32 v[208:209], v[208:209], v[52:53]
    v_pk_mul_f32 v[210:211], v[210:211], v[54:55]
    v_exp_f32 v204, v204
    v_exp_f32 v205, v205
    v_exp_f32 v206, v206
    v_exp_f32 v207, v207
    v_exp_f32 v208, v208
    v_exp_f32 v209, v209
    v_exp_f32 v210, v210
    v_exp_f32 v211, v211
    v_pk_add_f32 v[204:205], v[204:205], v[244:245]
    v_pk_add_f32 v[206:207], v[206:207], v[244:245]
    v_pk_add_f32 v[208:209], v[208:209], v[244:245]
    v_pk_add_f32 v[210:211], v[210:211], v[244:245]
    v_rcp_f32 v204, v204
    v_rcp_f32 v205, v205
    v_rcp_f32 v206, v206
    v_rcp_f32 v207, v207
    v_rcp_f32 v208, v208
    v_rcp_f32 v209, v209
    v_rcp_f32 v210, v210
    v_rcp_f32 v211, v211
    v_pk_mul_f32 v[48:49], v[48:49], v[204:205]
    v_pk_mul_f32 v[50:51], v[50:51], v[206:207]
    v_pk_mul_f32 v[52:53], v[52:53], v[208:209]
    v_pk_mul_f32 v[54:55], v[54:55], v[210:211]
    v_pk_mul_f32 v[204:205], v[56:57], v[56:57]
    v_pk_mul_f32 v[206:207], v[58:59], v[58:59]
    v_pk_mul_f32 v[208:209], v[60:61], v[60:61]
    v_pk_mul_f32 v[210:211], v[62:63], v[62:63]
    v_pk_fma_f32 v[204:205], v[204:205], v[242:243], v[240:241]
    v_pk_fma_f32 v[206:207], v[206:207], v[242:243], v[240:241]
    v_pk_fma_f32 v[208:209], v[208:209], v[242:243], v[240:241]
    v_pk_fma_f32 v[210:211], v[210:211], v[242:243], v[240:241]
    v_pk_mul_f32 v[204:205], v[204:205], v[56:57]
    v_pk_mul_f32 v[206:207], v[206:207], v[58:59]
    v_pk_mul_f32 v[208:209], v[208:209], v[60:61]
    v_pk_mul_f32 v[210:211], v[210:211], v[62:63]
    v_exp_f32 v204, v204
    v_exp_f32 v205, v205
    v_exp_f32 v206, v206
    v_exp_f32 v207, v207
    v_exp_f32 v208, v208
    v_exp_f32 v209, v209
    v_exp_f32 v210, v210
    v_exp_f32 v211, v211
    v_pk_add_f32 v[204:205], v[204:205], v[244:245]
    v_pk_add_f32 v[206:207], v[206:207], v[244:245]
    v_pk_add_f32 v[208:209], v[208:209], v[244:245]
    v_pk_add_f32 v[210:211], v[210:211], v[244:245]
    v_rcp_f32 v204, v204
    v_rcp_f32 v205, v205
    v_rcp_f32 v206, v206
    v_rcp_f32 v207, v207
    v_rcp_f32 v208, v208
    v_rcp_f32 v209, v209
    v_rcp_f32 v210, v210
    v_rcp_f32 v211, v211
    v_pk_mul_f32 v[56:57], v[56:57], v[204:205]
    v_pk_mul_f32 v[58:59], v[58:59], v[206:207]
    v_pk_mul_f32 v[60:61], v[60:61], v[208:209]
    v_pk_mul_f32 v[62:63], v[62:63], v[210:211]
    v_pk_mul_f32 v[204:205], v[64:65], v[64:65]
    v_pk_mul_f32 v[206:207], v[66:67], v[66:67]
    v_pk_mul_f32 v[208:209], v[68:69], v[68:69]
    v_pk_mul_f32 v[210:211], v[70:71], v[70:71]
    v_pk_fma_f32 v[204:205], v[204:205], v[242:243], v[240:241]
    v_pk_fma_f32 v[206:207], v[206:207], v[242:243], v[240:241]
    v_pk_fma_f32 v[208:209], v[208:209], v[242:243], v[240:241]
    v_pk_fma_f32 v[210:211], v[210:211], v[242:243], v[240:241]
    v_pk_mul_f32 v[204:205], v[204:205], v[64:65]
    v_pk_mul_f32 v[206:207], v[206:207], v[66:67]
    v_pk_mul_f32 v[208:209], v[208:209], v[68:69]
    v_pk_mul_f32 v[210:211], v[210:211], v[70:71]
    v_exp_f32 v204, v204
    v_exp_f32 v205, v205
    v_exp_f32 v206, v206
    v_exp_f32 v207, v207
    v_exp_f32 v208, v208
    v_exp_f32 v209, v209
    v_exp_f32 v210, v210
    v_exp_f32 v211, v211
    v_pk_add_f32 v[204:205], v[204:205], v[244:245]
    v_pk_add_f32 v[206:207], v[206:207], v[244:245]
    v_pk_add_f32 v[208:209], v[208:209], v[244:245]
    v_pk_add_f32 v[210:211], v[210:211], v[244:245]
    v_rcp_f32 v204, v204
    v_rcp_f32 v205, v205
    v_rcp_f32 v206, v206
    v_rcp_f32 v207, v207
    v_rcp_f32 v208, v208
    v_rcp_f32 v209, v209
    v_rcp_f32 v210, v210
    v_rcp_f32 v211, v211
    v_pk_mul_f32 v[64:65], v[64:65], v[204:205]
    v_pk_mul_f32 v[66:67], v[66:67], v[206:207]
    v_pk_mul_f32 v[68:69], v[68:69], v[208:209]
    v_pk_mul_f32 v[70:71], v[70:71], v[210:211]
    v_pk_mul_f32 v[204:205], v[72:73], v[72:73]
    v_pk_mul_f32 v[206:207], v[74:75], v[74:75]
    v_pk_mul_f32 v[208:209], v[76:77], v[76:77]
    v_pk_mul_f32 v[210:211], v[78:79], v[78:79]
    v_pk_fma_f32 v[204:205], v[204:205], v[242:243], v[240:241]
    v_pk_fma_f32 v[206:207], v[206:207], v[242:243], v[240:241]
    v_pk_fma_f32 v[208:209], v[208:209], v[242:243], v[240:241]
    v_pk_fma_f32 v[210:211], v[210:211], v[242:243], v[240:241]
    v_pk_mul_f32 v[204:205], v[204:205], v[72:73]
    v_pk_mul_f32 v[206:207], v[206:207], v[74:75]
    v_pk_mul_f32 v[208:209], v[208:209], v[76:77]
    v_pk_mul_f32 v[210:211], v[210:211], v[78:79]
    v_exp_f32 v204, v204
    v_exp_f32 v205, v205
    v_exp_f32 v206, v206
    v_exp_f32 v207, v207
    v_exp_f32 v208, v208
    v_exp_f32 v209, v209
    v_exp_f32 v210, v210
    v_exp_f32 v211, v211
    v_pk_add_f32 v[204:205], v[204:205], v[244:245]
    v_pk_add_f32 v[206:207], v[206:207], v[244:245]
    v_pk_add_f32 v[208:209], v[208:209], v[244:245]
    v_pk_add_f32 v[210:211], v[210:211], v[244:245]
    v_rcp_f32 v204, v204
    v_rcp_f32 v205, v205
    v_rcp_f32 v206, v206
    v_rcp_f32 v207, v207
    v_rcp_f32 v208, v208
    v_rcp_f32 v209, v209
    v_rcp_f32 v210, v210
    v_rcp_f32 v211, v211
    v_pk_mul_f32 v[72:73], v[72:73], v[204:205]
    v_pk_mul_f32 v[74:75], v[74:75], v[206:207]
    v_pk_mul_f32 v[76:77], v[76:77], v[208:209]
    v_pk_mul_f32 v[78:79], v[78:79], v[210:211]
    v_pk_mul_f32 v[212:213], v[8:9], v[8:9]
    v_pk_mul_f32 v[214:215], v[10:11], v[10:11]
    v_pk_mul_f32 v[216:217], v[12:13], v[12:13]
    v_pk_mul_f32 v[218:219], v[14:15], v[14:15]
    v_pk_add_f32 v[204:205], v[8:9], v[16:17]
    v_pk_fma_f32 v[212:213], v[16:17], v[16:17], v[212:213]
    v_pk_add_f32 v[206:207], v[10:11], v[18:19]
    v_pk_fma_f32 v[214:215], v[18:19], v[18:19], v[214:215]
    v_pk_add_f32 v[208:209], v[12:13], v[20:21]
    v_pk_fma_f32 v[216:217], v[20:21], v[20:21], v[216:217]
    v_pk_add_f32 v[210:211], v[14:15], v[22:23]
    v_pk_fma_f32 v[218:219], v[22:23], v[22:23], v[218:219]
    v_pk_add_f32 v[204:205], v[204:205], v[24:25]
    v_pk_fma_f32 v[212:213], v[24:25], v[24:25], v[212:213]
    v_pk_add_f32 v[206:207], v[206:207], v[26:27]
    v_pk_fma_f32 v[214:215], v[26:27], v[26:27], v[214:215]
    v_pk_add_f32 v[208:209], v[208:209], v[28:29]
    v_pk_fma_f32 v[216:217], v[28:29], v[28:29], v[216:217]
    v_pk_add_f32 v[210:211], v[210:211], v[30:31]
    v_pk_fma_f32 v[218:219], v[30:31], v[30:31], v[218:219]
    v_pk_add_f32 v[204:205], v[204:205], v[32:33]
    v_pk_fma_f32 v[212:213], v[32:33], v[32:33], v[212:213]
    v_pk_add_f32 v[206:207], v[206:207], v[34:35]
    v_pk_fma_f32 v[214:215], v[34:35], v[34:35], v[214:215]
    v_pk_add_f32 v[208:209], v[208:209], v[36:37]
    v_pk_fma_f32 v[216:217], v[36:37], v[36:37], v[216:217]
    v_pk_add_f32 v[210:211], v[210:211], v[38:39]
    v_pk_fma_f32 v[218:219], v[38:39], v[38:39], v[218:219]
    v_pk_add_f32 v[204:205], v[204:205], v[40:41]
    v_pk_fma_f32 v[212:213], v[40:41], v[40:41], v[212:213]
    v_pk_add_f32 v[206:207], v[206:207], v[42:43]
    v_pk_fma_f32 v[214:215], v[42:43], v[42:43], v[214:215]
    v_pk_add_f32 v[208:209], v[208:209], v[44:45]
    v_pk_fma_f32 v[216:217], v[44:45], v[44:45], v[216:217]
    v_pk_add_f32 v[210:211], v[210:211], v[46:47]
    v_pk_fma_f32 v[218:219], v[46:47], v[46:47], v[218:219]
    v_pk_add_f32 v[204:205], v[204:205], v[48:49]
    v_pk_fma_f32 v[212:213], v[48:49], v[48:49], v[212:213]
    v_pk_add_f32 v[206:207], v[206:207], v[50:51]
    v_pk_fma_f32 v[214:215], v[50:51], v[50:51], v[214:215]
    v_pk_add_f32 v[208:209], v[208:209], v[52:53]
    v_pk_fma_f32 v[216:217], v[52:53], v[52:53], v[216:217]
    v_pk_add_f32 v[210:211], v[210:211], v[54:55]
    v_pk_fma_f32 v[218:219], v[54:55], v[54:55], v[218:219]
    v_pk_add_f32 v[204:205], v[204:205], v[56:57]
    v_pk_fma_f32 v[212:213], v[56:57], v[56:57], v[212:213]
    v_pk_add_f32 v[206:207], v[206:207], v[58:59]
    v_pk_fma_f32 v[214:215], v[58:59], v[58:59], v[214:215]
    v_pk_add_f32 v[208:209], v[208:209], v[60:61]
    v_pk_fma_f32 v[216:217], v[60:61], v[60:61], v[216:217]
    v_pk_add_f32 v[210:211], v[210:211], v[62:63]
    v_pk_fma_f32 v[218:219], v[62:63], v[62:63], v[218:219]
    v_pk_add_f32 v[204:205], v[204:205], v[64:65]
    v_pk_fma_f32 v[212:213], v[64:65], v[64:65], v[212:213]
    v_pk_add_f32 v[206:207], v[206:207], v[66:67]
    v_pk_fma_f32 v[214:215], v[66:67], v[66:67], v[214:215]
    v_pk_add_f32 v[208:209], v[208:209], v[68:69]
    v_pk_fma_f32 v[216:217], v[68:69], v[68:69], v[216:217]
    v_pk_add_f32 v[210:211], v[210:211], v[70:71]
    v_pk_fma_f32 v[218:219], v[70:71], v[70:71], v[218:219]
    v_pk_add_f32 v[204:205], v[204:205], v[72:73]
    v_pk_fma_f32 v[212:213], v[72:73], v[72:73], v[212:213]
    v_pk_add_f32 v[206:207], v[206:207], v[74:75]
    v_pk_fma_f32 v[214:215], v[74:75], v[74:75], v[214:215]
    v_pk_add_f32 v[208:209], v[208:209], v[76:77]
    v_pk_fma_f32 v[216:217], v[76:77], v[76:77], v[216:217]
    v_pk_add_f32 v[210:211], v[210:211], v[78:79]
    v_pk_fma_f32 v[218:219], v[78:79], v[78:79], v[218:219]
    s_nop 1
    v_add_f32_dpp v204, v204, v204 row_ror:8 row_mask:0xf bank_mask:0x3
    v_add_f32_dpp v204, v208, v208 row_ror:8 row_mask:0xf bank_mask:0xc
    v_add_f32_dpp v205, v205, v205 row_ror:8 row_mask:0xf bank_mask:0x3
    v_add_f32_dpp v205, v209, v209 row_ror:8 row_mask:0xf bank_mask:0xc
    v_add_f32_dpp v206, v206, v206 row_ror:8 row_mask:0xf bank_mask:0x3
    v_add_f32_dpp v206, v210, v210 row_ror:8 row_mask:0xf bank_mask:0xc
    v_add_f32_dpp v207, v207, v207 row_ror:8 row_mask:0xf bank_mask:0x3
    v_add_f32_dpp v207, v211, v211 row_ror:8 row_mask:0xf bank_mask:0xc
    v_add_f32_dpp v212, v212, v212 row_ror:8 row_mask:0xf bank_mask:0x3
    v_add_f32_dpp v212, v216, v216 row_ror:8 row_mask:0xf bank_mask:0xc
    v_add_f32_dpp v213, v213, v213 row_ror:8 row_mask:0xf bank_mask:0x3
    v_add_f32_dpp v213, v217, v217 row_ror:8 row_mask:0xf bank_mask:0xc
    v_add_f32_dpp v214, v214, v214 row_ror:8 row_mask:0xf bank_mask:0x3
    v_add_f32_dpp v214, v218, v218 row_ror:8 row_mask:0xf bank_mask:0xc
    v_add_f32_dpp v215, v215, v215 row_ror:8 row_mask:0xf bank_mask:0x3
    v_add_f32_dpp v215, v219, v219 row_ror:8 row_mask:0xf bank_mask:0xc
    v_add_f32_dpp v204, v204, v204 row_shl:4 row_mask:0xf bank_mask:0x5
    v_add_f32_dpp v204, v206, v206 row_shr:4 row_mask:0xf bank_mask:0xa
    v_add_f32_dpp v205, v205, v205 row_shl:4 row_mask:0xf bank_mask:0x5
    v_add_f32_dpp v205, v207, v207 row_shr:4 row_mask:0xf bank_mask:0xa
    v_add_f32_dpp v212, v212, v212 row_shl:4 row_mask:0xf bank_mask:0x5
    v_add_f32_dpp v212, v214, v214 row_shr:4 row_mask:0xf bank_mask:0xa
    v_add_f32_dpp v213, v213, v213 row_shl:4 row_mask:0xf bank_mask:0x5
    v_add_f32_dpp v213, v215, v215 row_shr:4 row_mask:0xf bank_mask:0xa
    s_nop 0
    v_add_f32_dpp v204, v204, v204 quad_perm:[1,0,3,2] row_mask:0xf bank_mask:0xf
    v_add_f32_dpp v205, v205, v205 quad_perm:[1,0,3,2] row_mask:0xf bank_mask:0xf
    v_add_f32_dpp v212, v212, v212 quad_perm:[1,0,3,2] row_mask:0xf bank_mask:0xf
    v_add_f32_dpp v213, v213, v213 quad_perm:[1,0,3,2] row_mask:0xf bank_mask:0xf
    v_add_f32_dpp v204, v204, v204 quad_perm:[2,3,0,1] row_mask:0xf bank_mask:0xf
    v_add_f32_dpp v205, v205, v205 quad_perm:[2,3,0,1] row_mask:0xf bank_mask:0xf
    v_add_f32_dpp v212, v212, v212 quad_perm:[2,3,0,1] row_mask:0xf bank_mask:0xf
    v_add_f32_dpp v213, v213, v213 quad_perm:[2,3,0,1] row_mask:0xf bank_mask:0xf
    s_waitcnt vmcnt(3)
    s_mov_b32 s70, 400000
L_nonce:
    v_readfirstlane_b32 s66, v247
    s_cmp_lg_u32 s66, 0
    s_cbranch_scc1 L_nonced
    s_sub_u32 s70, s70, 1
    s_cmp_eq_u32 s70, 0
    s_cbranch_scc1 L_nonced
    buffer_load_dword v247, v246, s[40:43], 0 offen sc1
    s_waitcnt vmcnt(0)
    s_branch L_nonce
L_nonced:
    v_and_b32 v246, 1, v0
    v_cmp_eq_u32 vcc, 1, v246
    v_lshrrev_b32 v248, 1, v0
    v_and_b32 v248, 6, v248
    v_or_b32 v248, v248, v246
    v_cndmask_b32 v220, v204, v205, vcc
    v_cndmask_b32 v222, v212, v213, vcc
    v_mov_b32 v221, s66
    v_mov_b32 v223, s66
    v_bfe_u32 v249, v0, 5, 1
    v_lshl_add_u32 v248, v249, 3, v248
    v_and_b32 v249, 16, v0
    v_add_lshl_u32 v248, v248, v249, 4
    s_lshl_b32 s67, s53, 2
    s_add_u32 s67, s67, s56
    s_lshl_b32 s67, s67, 13
    s_add_u32 s67, s67, 22020096
    s_lshl_b32 s57, s54, 9
    s_add_u32 s57, s57, s67
    s_mov_b32 s76, 0x33333333
    s_mov_b32 s77, 0x33333333
    s_mov_b64 exec, s[76:77]
    buffer_store_dwordx4 v[220:223], v248, s[32:35], s57 offen sc1
    s_mov_b64 exec, -1
    s_nop 1
    s_mov_b32 s69, 0
L_cB:
    s_waitcnt lgkmcnt(14)
    v_mfma_f32_16x16x32_bf16 v[80:83], v[168:171], v[152:155], v[80:83]
    ds_read_b128 v[160:163], v237 offset:0
    ds_read_b128 v[164:167], v237 offset:2048
    v_mfma_f32_16x16x32_bf16 v[84:87], v[168:171], v[156:159], v[84:87]
    ds_read_b64_tr_b16 v[168:169], v239 offset:9216
    v_mfma_f32_16x16x32_bf16 v[88:91], v[172:175], v[152:155], v[88:91]
    ds_read_b64_tr_b16 v[170:171], v239 offset:11520
    v_mfma_f32_16x16x32_bf16 v[92:95], v[172:175], v[156:159], v[92:95]
    ds_read_b64_tr_b16 v[172:173], v239 offset:9248
    s_waitcnt lgkmcnt(14)
    v_mfma_f32_16x16x32_bf16 v[96:99], v[176:179], v[152:155], v[96:99]
    ds_read_b64_tr_b16 v[174:175], v239 offset:11552
    v_mfma_f32_16x16x32_bf16 v[100:103], v[176:179], v[156:159], v[100:103]
    ds_read_b64_tr_b16 v[176:177], v239 offset:9280
    v_mfma_f32_16x16x32_bf16 v[104:107], v[180:183], v[152:155], v[104:107]
    ds_read_b64_tr_b16 v[178:179], v239 offset:11584
    v_mfma_f32_16x16x32_bf16 v[108:111], v[180:183], v[156:159], v[108:111]
    ds_read_b64_tr_b16 v[180:181], v239 offset:9312
    s_waitcnt lgkmcnt(14)
    v_mfma_f32_16x16x32_bf16 v[112:115], v[184:187], v[152:155], v[112:115]
    ds_read_b64_tr_b16 v[182:183], v239 offset:11616
    v_mfma_f32_16x16x32_bf16 v[116:119], v[184:187], v[156:159], v[116:119]
    ds_read_b64_tr_b16 v[184:185], v239 offset:9344
    v_mfma_f32_16x16x32_bf16 v[120:123], v[188:191], v[152:155], v[120:123]
    ds_read_b64_tr_b16 v[186:187], v239 offset:11648
    v_mfma_f32_16x16x32_bf16 v[124:127], v[188:191], v[156:159], v[124:127]
    ds_read_b64_tr_b16 v[188:189], v239 offset:9376
    s_waitcnt lgkmcnt(14)
    v_mfma_f32_16x16x32_bf16 v[128:131], v[192:195], v[152:155], v[128:131]
    ds_read_b64_tr_b16 v[190:191], v239 offset:11680
    v_mfma_f32_16x16x32_bf16 v[132:135], v[192:195], v[156:159], v[132:135]
    ds_read_b64_tr_b16 v[192:193], v239 offset:9408
    v_mfma_f32_16x16x32_bf16 v[136:139], v[196:199], v[152:155], v[136:139]
    ds_read_b64_tr_b16 v[194:195], v239 offset:11712
    v_mfma_f32_16x16x32_bf16 v[140:143], v[196:199], v[156:159], v[140:143]
    ds_read_b64_tr_b16 v[196:197], v239 offset:9440
    s_waitcnt lgkmcnt(14)
    v_mfma_f32_16x16x32_bf16 v[144:147], v[200:203], v[152:155], v[144:147]
    ds_read_b64_tr_b16 v[198:199], v239 offset:11744
    v_mfma_f32_16x16x32_bf16 v[148:151], v[200:203], v[156:159], v[148:151]
    ds_read_b64_tr_b16 v[200:201], v239 offset:9472
    ds_read_b64_tr_b16 v[202:203], v239 offset:11776
    s_cmp_eq_u32 s69, 8
    s_cbranch_scc1 L_cB_exit
    s_waitcnt lgkmcnt(14)
    v_mfma_f32_16x16x32_bf16 v[80:83], v[168:171], v[160:163], v[80:83]
    s_add_u32 s61, s61, 1
    s_and_b32 s61, s61, 3
    s_cselect_b32 s62, 34816, s65
    v_mfma_f32_16x16x32_bf16 v[84:87], v[168:171], v[164:167], v[84:87]
    v_add_u32 v236, s62, v236
    v_mfma_f32_16x16x32_bf16 v[88:91], v[172:175], v[160:163], v[88:91]
    v_add_u32 v237, s62, v237
    v_mfma_f32_16x16x32_bf16 v[92:95], v[172:175], v[164:167], v[92:95]
    v_add_u32 v238, s62, v238
    s_waitcnt lgkmcnt(12)
    v_mfma_f32_16x16x32_bf16 v[96:99], v[176:179], v[160:163], v[96:99]
    v_add_u32 v239, s62, v239
    v_mfma_f32_16x16x32_bf16 v[100:103], v[176:179], v[164:167], v[100:103]
    s_cmp_lg_u32 s69, 1
    s_cbranch_scc1 L_sk_5
    s_add_u32 s57, s67, 4096
    buffer_load_dwordx4 v[204:207], v1, s[32:35], s67 offen offset:0 sc1
    buffer_load_dwordx4 v[208:211], v1, s[32:35], s67 offen offset:1024 sc1
    buffer_load_dwordx4 v[212:215], v1, s[32:35], s67 offen offset:2048 sc1
    buffer_load_dwordx4 v[216:219], v1, s[32:35], s67 offen offset:3072 sc1
    buffer_load_dwordx4 v[220:223], v1, s[32:35], s57 offen offset:0 sc1
    buffer_load_dwordx4 v[224:227], v1, s[32:35], s57 offen offset:1024 sc1
    buffer_load_dwordx4 v[228:231], v1, s[32:35], s57 offen offset:2048 sc1
    buffer_load_dwordx4 v[232:235], v1, s[32:35], s57 offen offset:3072 sc1
L_sk_5:
    s_cmp_lg_u32 s69, 2
    s_cbranch_scc1 L_sk_6
    s_mov_b32 s70, 400000
L_st_chk:
    s_waitcnt vmcnt(0)
    v_min3_u32 v246, v205, v207, v209
    v_max3_u32 v247, v205, v207, v209
    v_min3_u32 v246, v246, v211, v213
    v_max3_u32 v247, v247, v211, v213
    v_min3_u32 v246, v246, v215, v217
    v_max3_u32 v247, v247, v215, v217
    v_min3_u32 v246, v246, v219, v221
    v_max3_u32 v247, v247, v219, v221
    v_min3_u32 v246, v246, v223, v225
    v_max3_u32 v247, v247, v223, v225
    v_min3_u32 v246, v246, v227, v229
    v_max3_u32 v247, v247, v227, v229
    v_min3_u32 v246, v246, v231, v233
    v_max3_u32 v247, v247, v231, v233
    v_min_u32 v246, v246, v235
    v_max_u32 v247, v247, v235
    v_cmp_ne_u32 vcc, s66, v246
    v_cmp_ne_u32 s[78:79], s66, v247
    s_or_b64 vcc, vcc, s[78:79]
    s_cbranch_scc0 L_st_ok
    s_sub_u32 s70, s70, 1
    s_cmp_eq_u32 s70, 0
    s_cbranch_scc1 L_st_ok
    s_sleep 4
    s_mov_b64 exec, vcc
    s_add_u32 s57, s67, 4096
    buffer_load_dwordx4 v[204:207], v1, s[32:35], s67 offen offset:0 sc1
    buffer_load_dwordx4 v[208:211], v1, s[32:35], s67 offen offset:1024 sc1
    buffer_load_dwordx4 v[212:215], v1, s[32:35], s67 offen offset:2048 sc1
    buffer_load_dwordx4 v[216:219], v1, s[32:35], s67 offen offset:3072 sc1
    buffer_load_dwordx4 v[220:223], v1, s[32:35], s57 offen offset:0 sc1
    buffer_load_dwordx4 v[224:227], v1, s[32:35], s57 offen offset:1024 sc1
    buffer_load_dwordx4 v[228:231], v1, s[32:35], s57 offen offset:2048 sc1
    buffer_load_dwordx4 v[232:235], v1, s[32:35], s57 offen offset:3072 sc1
    s_mov_b64 exec, -1
    s_branch L_st_chk
L_st_ok:
    v_add_f32 v204, v204, v208
    v_add_f32 v206, v206, v210
    v_add_f32 v212, v212, v216
    v_add_f32 v214, v214, v218
    v_add_f32 v220, v220, v224
    v_add_f32 v222, v222, v226
    v_add_f32 v228, v228, v232
    v_add_f32 v230, v230, v234
    v_add_f32 v204, v204, v212
    v_add_f32 v206, v206, v214
    v_add_f32 v220, v220, v228
    v_add_f32 v222, v222, v230
    v_add_f32 v204, v204, v220
    v_add_f32 v206, v206, v222
    v_mov_b32 v205, v204
    v_mov_b32 v207, v206
    s_mov_b32 s57, 0x39e38e39
    s_mov_b32 s58, 0x3727c5ac
    v_permlane32_swap_b32 v204, v205
    v_permlane32_swap_b32 v206, v207
    s_nop 1
    v_add_f32 v204, v204, v205
    v_add_f32 v206, v206, v207
    v_mul_f32 v204, s57, v204
    v_mul_f32 v206, s57, v206
    v_fma_f32 v206, -v204, v204, v206
    v_max_f32 v206, 0, v206
    v_add_f32 v206, s58, v206
    v_rsq_f32 v206, v206
    s_nop 0
    v_mul_f32 v204, -v204, v206
    s_mul_i32 s57, s54, 589824
    s_lshl_b32 s58, s53, 2
    v_mov_b32_dpp v212, v206 row_newbcast:0 row_mask:0x3 bank_mask:0xf
    v_mov_b32_dpp v212, v206 row_newbcast:8 row_mask:0xc bank_mask:0xf
    v_mov_b32_dpp v213, v206 row_newbcast:1 row_mask:0x3 bank_mask:0xf
    v_mov_b32_dpp v213, v206 row_newbcast:9 row_mask:0xc bank_mask:0xf
    v_mov_b32_dpp v214, v206 row_newbcast:2 row_mask:0x3 bank_mask:0xf
    v_mov_b32_dpp v214, v206 row_newbcast:10 row_mask:0xc bank_mask:0xf
    v_mov_b32_dpp v215, v206 row_newbcast:3 row_mask:0x3 bank_mask:0xf
    v_mov_b32_dpp v215, v206 row_newbcast:11 row_mask:0xc bank_mask:0xf
    v_mov_b32_dpp v216, v206 row_newbcast:4 row_mask:0x3 bank_mask:0xf
    v_mov_b32_dpp v216, v206 row_newbcast:12 row_mask:0xc bank_mask:0xf
    v_mov_b32_dpp v217, v206 row_newbcast:5 row_mask:0x3 bank_mask:0xf
    v_mov_b32_dpp v217, v206 row_newbcast:13 row_mask:0xc bank_mask:0xf
    v_mov_b32_dpp v218, v206 row_newbcast:6 row_mask:0x3 bank_mask:0xf
    v_mov_b32_dpp v218, v206 row_newbcast:14 row_mask:0xc bank_mask:0xf
    v_mov_b32_dpp v219, v206 row_newbcast:7 row_mask:0x3 bank_mask:0xf
    v_mov_b32_dpp v219, v206 row_newbcast:15 row_mask:0xc bank_mask:0xf
    v_mov_b32_dpp v220, v204 row_newbcast:0 row_mask:0x3 bank_mask:0xf
    v_mov_b32_dpp v220, v204 row_newbcast:8 row_mask:0xc bank_mask:0xf
    v_mov_b32_dpp v221, v204 row_newbcast:1 row_mask:0x3 bank_mask:0xf
    v_mov_b32_dpp v221, v204 row_newbcast:9 row_mask:0xc bank_mask:0xf
    v_mov_b32_dpp v222, v204 row_newbcast:2 row_mask:0x3 bank_mask:0xf
    v_mov_b32_dpp v222, v204 row_newbcast:10 row_mask:0xc bank_mask:0xf
    v_mov_b32_dpp v223, v204 row_newbcast:3 row_mask:0x3 bank_mask:0xf
    v_mov_b32_dpp v223, v204 row_newbcast:11 row_mask:0xc bank_mask:0xf
    v_mov_b32_dpp v224, v204 row_newbcast:4 row_mask:0x3 bank_mask:0xf
    v_mov_b32_dpp v224, v204 row_newbcast:12 row_mask:0xc bank_mask:0xf
    v_mov_b32_dpp v225, v204 row_newbcast:5 row_mask:0x3 bank_mask:0xf
    v_mov_b32_dpp v225, v204 row_newbcast:13 row_mask:0xc bank_mask:0xf
    v_mov_b32_dpp v226, v204 row_newbcast:6 row_mask:0x3 bank_mask:0xf
    v_mov_b32_dpp v226, v204 row_newbcast:14 row_mask:0xc bank_mask:0xf
    v_mov_b32_dpp v227, v204 row_newbcast:7 row_mask:0x3 bank_mask:0xf
    v_mov_b32_dpp v227, v204 row_newbcast:15 row_mask:0xc bank_mask:0xf
    s_add_u32 s58, s58, s56
    s_mul_i32 s58, s58, 9216
    s_add_u32 s57, s57, s58
    v_pk_fma_f32 v[8:9], v[8:9], v[212:213], v[220:221]
    v_pk_fma_f32 v[10:11], v[10:11], v[214:215], v[222:223]
    v_pk_fma_f32 v[12:13], v[12:13], v[216:217], v[224:225]
    v_pk_fma_f32 v[14:15], v[14:15], v[218:219], v[226:227]
    v_cvt_pk_bf16_f32 v8, v8, v9
    v_cvt_pk_bf16_f32 v9, v10, v11
    v_cvt_pk_bf16_f32 v10, v12, v13
    v_cvt_pk_bf16_f32 v11, v14, v15
    buffer_store_dwordx4 v[8:11], v1, s[32:35], s57 offen offset:0 sc1
    v_pk_fma_f32 v[16:17], v[16:17], v[212:213], v[220:221]
    v_pk_fma_f32 v[18:19], v[18:19], v[214:215], v[222:223]
    v_pk_fma_f32 v[20:21], v[20:21], v[216:217], v[224:225]
    v_pk_fma_f32 v[22:23], v[22:23], v[218:219], v[226:227]
    v_cvt_pk_bf16_f32 v16, v16, v17
    v_cvt_pk_bf16_f32 v17, v18, v19
    v_cvt_pk_bf16_f32 v18, v20, v21
    v_cvt_pk_bf16_f32 v19, v22, v23
    buffer_store_dwordx4 v[16:19], v1, s[32:35], s57 offen offset:1024 sc1
    v_pk_fma_f32 v[24:25], v[24:25], v[212:213], v[220:221]
    v_pk_fma_f32 v[26:27], v[26:27], v[214:215], v[222:223]
    v_pk_fma_f32 v[28:29], v[28:29], v[216:217], v[224:225]
    v_pk_fma_f32 v[30:31], v[30:31], v[218:219], v[226:227]
    v_cvt_pk_bf16_f32 v24, v24, v25
    v_cvt_pk_bf16_f32 v25, v26, v27
    v_cvt_pk_bf16_f32 v26, v28, v29
    v_cvt_pk_bf16_f32 v27, v30, v31
    buffer_store_dwordx4 v[24:27], v1, s[32:35], s57 offen offset:2048 sc1
    v_pk_fma_f32 v[32:33], v[32:33], v[212:213], v[220:221]
    v_pk_fma_f32 v[34:35], v[34:35], v[214:215], v[222:223]
    v_pk_fma_f32 v[36:37], v[36:37], v[216:217], v[224:225]
    v_pk_fma_f32 v[38:39], v[38:39], v[218:219], v[226:227]
    v_cvt_pk_bf16_f32 v32, v32, v33
    v_cvt_pk_bf16_f32 v33, v34, v35
    v_cvt_pk_bf16_f32 v34, v36, v37
    v_cvt_pk_bf16_f32 v35, v38, v39
    buffer_store_dwordx4 v[32:35], v1, s[32:35], s57 offen offset:3072 sc1
    v_pk_fma_f32 v[40:41], v[40:41], v[212:213], v[220:221]
    v_pk_fma_f32 v[42:43], v[42:43], v[214:215], v[222:223]
    v_pk_fma_f32 v[44:45], v[44:45], v[216:217], v[224:225]
    v_pk_fma_f32 v[46:47], v[46:47], v[218:219], v[226:227]
    v_cvt_pk_bf16_f32 v40, v40, v41
    v_cvt_pk_bf16_f32 v41, v42, v43
    v_cvt_pk_bf16_f32 v42, v44, v45
    v_cvt_pk_bf16_f32 v43, v46, v47
    s_add_u32 s57, s57, 4096
    buffer_store_dwordx4 v[40:43], v1, s[32:35], s57 offen offset:0 sc1
    v_pk_fma_f32 v[48:49], v[48:49], v[212:213], v[220:221]
    v_pk_fma_f32 v[50:51], v[50:51], v[214:215], v[222:223]
    v_pk_fma_f32 v[52:53], v[52:53], v[216:217], v[224:225]
    v_pk_fma_f32 v[54:55], v[54:55], v[218:219], v[226:227]
    v_cvt_pk_bf16_f32 v48, v48, v49
    v_cvt_pk_bf16_f32 v49, v50, v51
    v_cvt_pk_bf16_f32 v50, v52, v53
    v_cvt_pk_bf16_f32 v51, v54, v55
    buffer_store_dwordx4 v[48:51], v1, s[32:35], s57 offen offset:1024 sc1
    v_pk_fma_f32 v[56:57], v[56:57], v[212:213], v[220:221]
    v_pk_fma_f32 v[58:59], v[58:59], v[214:215], v[222:223]
    v_pk_fma_f32 v[60:61], v[60:61], v[216:217], v[224:225]
    v_pk_fma_f32 v[62:63], v[62:63], v[218:219], v[226:227]
    v_cvt_pk_bf16_f32 v56, v56, v57
    v_cvt_pk_bf16_f32 v57, v58, v59
    v_cvt_pk_bf16_f32 v58, v60, v61
    v_cvt_pk_bf16_f32 v59, v62, v63
    buffer_store_dwordx4 v[56:59], v1, s[32:35], s57 offen offset:2048 sc1
    v_pk_fma_f32 v[64:65], v[64:65], v[212:213], v[220:221]
    v_pk_fma_f32 v[66:67], v[66:67], v[214:215], v[222:223]
    v_pk_fma_f32 v[68:69], v[68:69], v[216:217], v[224:225]
    v_pk_fma_f32 v[70:71], v[70:71], v[218:219], v[226:227]
    v_cvt_pk_bf16_f32 v64, v64, v65
    v_cvt_pk_bf16_f32 v65, v66, v67
    v_cvt_pk_bf16_f32 v66, v68, v69
    v_cvt_pk_bf16_f32 v67, v70, v71
    buffer_store_dwordx4 v[64:67], v1, s[32:35], s57 offen offset:3072 sc1
    v_pk_fma_f32 v[72:73], v[72:73], v[212:213], v[220:221]
    v_pk_fma_f32 v[74:75], v[74:75], v[214:215], v[222:223]
    v_pk_fma_f32 v[76:77], v[76:77], v[216:217], v[224:225]
    v_pk_fma_f32 v[78:79], v[78:79], v[218:219], v[226:227]
    v_cvt_pk_bf16_f32 v72, v72, v73
    v_cvt_pk_bf16_f32 v73, v74, v75
    v_cvt_pk_bf16_f32 v74, v76, v77
    v_cvt_pk_bf16_f32 v75, v78, v79
    s_add_u32 s57, s57, 4096
    buffer_store_dwordx4 v[72:75], v1, s[32:35], s57 offen offset:0 sc1
L_sk_6:
    s_cmp_lg_u32 s69, 4
    s_cbranch_scc1 L_sk_7
    s_lshl_b32 s57, s54, 10
    s_lshl_b32 s58, s53, 4
    s_add_u32 s58, s58, s56
    s_lshl_b32 s58, s58, 2
    s_add_u32 s57, s57, s58
    s_add_u32 s57, s57, 22544384
    s_waitcnt vmcnt(0)
    v_mov_b32 v246, s66
    v_mov_b32 v247, 0
    s_mov_b64 exec, 1
    buffer_store_dword v246, v247, s[32:35], s57 offen sc1
    s_mov_b64 exec, -1
    v_lshlrev_b32 v204, 16, v2
    v_lshlrev_b32 v208, 16, v3
    v_mov_b32 v205, v204
    v_mov_b32 v209, v208
    v_mov_b32 v206, v204
    v_mov_b32 v210, v208
    v_mov_b32 v207, v204
    v_mov_b32 v211, v208
L_sk_7:
    s_waitcnt lgkmcnt(0)
    s_barrier
    v_mfma_f32_16x16x32_bf16 v[104:107], v[180:183], v[160:163], v[104:107]
    ds_read_b128 v[152:155], v236 offset:0
    ds_read_b128 v[156:159], v236 offset:2048
    v_mfma_f32_16x16x32_bf16 v[108:111], v[180:183], v[164:167], v[108:111]
    ds_read_b64_tr_b16 v[168:169], v239 offset:0
    ds_read_b64_tr_b16 v[170:171], v239 offset:2304
    v_mfma_f32_16x16x32_bf16 v[112:115], v[184:187], v[160:163], v[112:115]
    ds_read_b64_tr_b16 v[172:173], v239 offset:32
    ds_read_b64_tr_b16 v[174:175], v239 offset:2336
    v_mfma_f32_16x16x32_bf16 v[116:119], v[184:187], v[164:167], v[116:119]
    ds_read_b64_tr_b16 v[176:177], v239 offset:64
    ds_read_b64_tr_b16 v[178:179], v239 offset:2368
    v_mfma_f32_16x16x32_bf16 v[120:123], v[188:191], v[160:163], v[120:123]
    ds_read_b64_tr_b16 v[180:181], v239 offset:96
    ds_read_b64_tr_b16 v[182:183], v239 offset:2400
    v_mfma_f32_16x16x32_bf16 v[124:127], v[188:191], v[164:167], v[124:127]
    ds_read_b64_tr_b16 v[184:185], v239 offset:128
    ds_read_b64_tr_b16 v[186:187], v239 offset:2432
    v_mfma_f32_16x16x32_bf16 v[128:131], v[192:195], v[160:163], v[128:131]
    ds_read_b64_tr_b16 v[188:189], v239 offset:160
    ds_read_b64_tr_b16 v[190:191], v239 offset:2464
    v_mfma_f32_16x16x32_bf16 v[132:135], v[192:195], v[164:167], v[132:135]
    ds_read_b64_tr_b16 v[192:193], v239 offset:192
    v_mfma_f32_16x16x32_bf16 v[136:139], v[196:199], v[160:163], v[136:139]
    ds_read_b64_tr_b16 v[194:195], v239 offset:2496
    v_mfma_f32_16x16x32_bf16 v[140:143], v[196:199], v[164:167], v[140:143]
    ds_read_b64_tr_b16 v[196:197], v239 offset:224
    v_mfma_f32_16x16x32_bf16 v[144:147], v[200:203], v[160:163], v[144:147]
    ds_read_b64_tr_b16 v[198:199], v239 offset:2528
    v_mfma_f32_16x16x32_bf16 v[148:151], v[200:203], v[164:167], v[148:151]
    ds_read_b64_tr_b16 v[200:201], v239 offset:256
    ds_read_b64_tr_b16 v[202:203], v239 offset:2560
    s_add_u32 s69, s69, 1
    s_branch L_cB
L_cB_exit:
    s_waitcnt lgkmcnt(14)
    v_mfma_f32_16x16x32_bf16 v[80:83], v[168:171], v[160:163], v[80:83]
    v_mfma_f32_16x16x32_bf16 v[84:87], v[168:171], v[164:167], v[84:87]
    v_mfma_f32_16x16x32_bf16 v[88:91], v[172:175], v[160:163], v[88:91]
    v_mfma_f32_16x16x32_bf16 v[92:95], v[172:175], v[164:167], v[92:95]
    s_waitcnt lgkmcnt(12)
    v_mfma_f32_16x16x32_bf16 v[96:99], v[176:179], v[160:163], v[96:99]
    v_mfma_f32_16x16x32_bf16 v[100:103], v[176:179], v[164:167], v[100:103]
    s_waitcnt lgkmcnt(10)
    v_mfma_f32_16x16x32_bf16 v[104:107], v[180:183], v[160:163], v[104:107]
    v_mfma_f32_16x16x32_bf16 v[108:111], v[180:183], v[164:167], v[108:111]
    s_waitcnt lgkmcnt(8)
    v_mfma_f32_16x16x32_bf16 v[112:115], v[184:187], v[160:163], v[112:115]
    v_mfma_f32_16x16x32_bf16 v[116:119], v[184:187], v[164:167], v[116:119]
    s_waitcnt lgkmcnt(6)
    v_mfma_f32_16x16x32_bf16 v[120:123], v[188:191], v[160:163], v[120:123]
    v_mfma_f32_16x16x32_bf16 v[124:127], v[188:191], v[164:167], v[124:127]
    s_waitcnt lgkmcnt(4)
    v_mfma_f32_16x16x32_bf16 v[128:131], v[192:195], v[160:163], v[128:131]
    v_mfma_f32_16x16x32_bf16 v[132:135], v[192:195], v[164:167], v[132:135]
    s_waitcnt lgkmcnt(2)
    v_mfma_f32_16x16x32_bf16 v[136:139], v[196:199], v[160:163], v[136:139]
    v_mfma_f32_16x16x32_bf16 v[140:143], v[196:199], v[164:167], v[140:143]
    s_waitcnt lgkmcnt(0)
    v_mfma_f32_16x16x32_bf16 v[144:147], v[200:203], v[160:163], v[144:147]
    v_mfma_f32_16x16x32_bf16 v[148:151], v[200:203], v[164:167], v[148:151]
    s_add_u32 s61, s61, 1
    s_and_b32 s61, s61, 3
    s_cselect_b32 s62, 34816, s65
    v_add_u32 v236, s62, v236
    v_add_u32 v237, s62, v237
    v_add_u32 v238, s62, v238
    v_add_u32 v239, s62, v239
    s_nop 1
    v_pk_mul_f32 v[212:213], v[80:81], v[80:81]
    v_pk_mul_f32 v[214:215], v[82:83], v[82:83]
    v_pk_mul_f32 v[216:217], v[84:85], v[84:85]
    v_pk_mul_f32 v[218:219], v[86:87], v[86:87]
    v_pk_fma_f32 v[212:213], v[212:213], v[242:243], v[240:241]
    v_pk_fma_f32 v[214:215], v[214:215], v[242:243], v[240:241]
    v_pk_fma_f32 v[216:217], v[216:217], v[242:243], v[240:241]
    v_pk_fma_f32 v[218:219], v[218:219], v[242:243], v[240:241]
    v_pk_mul_f32 v[212:213], v[212:213], v[80:81]
    v_pk_mul_f32 v[214:215], v[214:215], v[82:83]
    v_pk_mul_f32 v[216:217], v[216:217], v[84:85]
    v_pk_mul_f32 v[218:219], v[218:219], v[86:87]
    v_exp_f32 v212, v212
    v_exp_f32 v213, v213
    v_exp_f32 v214, v214
    v_exp_f32 v215, v215
    v_exp_f32 v216, v216
    v_exp_f32 v217, v217
    v_exp_f32 v218, v218
    v_exp_f32 v219, v219
    v_pk_add_f32 v[212:213], v[212:213], v[244:245]
    v_pk_add_f32 v[214:215], v[214:215], v[244:245]
    v_pk_add_f32 v[216:217], v[216:217], v[244:245]
    v_pk_add_f32 v[218:219], v[218:219], v[244:245]
    v_rcp_f32 v212, v212
    v_rcp_f32 v213, v213
    v_rcp_f32 v214, v214
    v_rcp_f32 v215, v215
    v_rcp_f32 v216, v216
    v_rcp_f32 v217, v217
    v_rcp_f32 v218, v218
    v_rcp_f32 v219, v219
    v_pk_mul_f32 v[80:81], v[80:81], v[212:213]
    v_pk_mul_f32 v[82:83], v[82:83], v[214:215]
    v_pk_mul_f32 v[84:85], v[84:85], v[216:217]
    v_pk_mul_f32 v[86:87], v[86:87], v[218:219]
    v_pk_mul_f32 v[212:213], v[88:89], v[88:89]
    v_pk_mul_f32 v[214:215], v[90:91], v[90:91]
    v_pk_mul_f32 v[216:217], v[92:93], v[92:93]
    v_pk_mul_f32 v[218:219], v[94:95], v[94:95]
    v_pk_fma_f32 v[212:213], v[212:213], v[242:243], v[240:241]
    v_pk_fma_f32 v[214:215], v[214:215], v[242:243], v[240:241]
    v_pk_fma_f32 v[216:217], v[216:217], v[242:243], v[240:241]
    v_pk_fma_f32 v[218:219], v[218:219], v[242:243], v[240:241]
    v_pk_mul_f32 v[212:213], v[212:213], v[88:89]
    v_pk_mul_f32 v[214:215], v[214:215], v[90:91]
    v_pk_mul_f32 v[216:217], v[216:217], v[92:93]
    v_pk_mul_f32 v[218:219], v[218:219], v[94:95]
    v_exp_f32 v212, v212
    v_exp_f32 v213, v213
    v_exp_f32 v214, v214
    v_exp_f32 v215, v215
    v_exp_f32 v216, v216
    v_exp_f32 v217, v217
    v_exp_f32 v218, v218
    v_exp_f32 v219, v219
    v_pk_add_f32 v[212:213], v[212:213], v[244:245]
    v_pk_add_f32 v[214:215], v[214:215], v[244:245]
    v_pk_add_f32 v[216:217], v[216:217], v[244:245]
    v_pk_add_f32 v[218:219], v[218:219], v[244:245]
    v_rcp_f32 v212, v212
    v_rcp_f32 v213, v213
    v_rcp_f32 v214, v214
    v_rcp_f32 v215, v215
    v_rcp_f32 v216, v216
    v_rcp_f32 v217, v217
    v_rcp_f32 v218, v218
    v_rcp_f32 v219, v219
    v_pk_mul_f32 v[88:89], v[88:89], v[212:213]
    v_pk_mul_f32 v[90:91], v[90:91], v[214:215]
    v_pk_mul_f32 v[92:93], v[92:93], v[216:217]
    v_pk_mul_f32 v[94:95], v[94:95], v[218:219]
    v_pk_mul_f32 v[212:213], v[96:97], v[96:97]
    v_pk_mul_f32 v[214:215], v[98:99], v[98:99]
    v_pk_mul_f32 v[216:217], v[100:101], v[100:101]
    v_pk_mul_f32 v[218:219], v[102:103], v[102:103]
    v_pk_fma_f32 v[212:213], v[212:213], v[242:243], v[240:241]
    v_pk_fma_f32 v[214:215], v[214:215], v[242:243], v[240:241]
    v_pk_fma_f32 v[216:217], v[216:217], v[242:243], v[240:241]
    v_pk_fma_f32 v[218:219], v[218:219], v[242:243], v[240:241]
    v_pk_mul_f32 v[212:213], v[212:213], v[96:97]
    v_pk_mul_f32 v[214:215], v[214:215], v[98:99]
    v_pk_mul_f32 v[216:217], v[216:217], v[100:101]
    v_pk_mul_f32 v[218:219], v[218:219], v[102:103]
    v_exp_f32 v212, v212
    v_exp_f32 v213, v213
    v_exp_f32 v214, v214
    v_exp_f32 v215, v215
    v_exp_f32 v216, v216
    v_exp_f32 v217, v217
    v_exp_f32 v218, v218
    v_exp_f32 v219, v219
    v_pk_add_f32 v[212:213], v[212:213], v[244:245]
    v_pk_add_f32 v[214:215], v[214:215], v[244:245]
    v_pk_add_f32 v[216:217], v[216:217], v[244:245]
    v_pk_add_f32 v[218:219], v[218:219], v[244:245]
    v_rcp_f32 v212, v212
    v_rcp_f32 v213, v213
    v_rcp_f32 v214, v214
    v_rcp_f32 v215, v215
    v_rcp_f32 v216, v216
    v_rcp_f32 v217, v217
    v_rcp_f32 v218, v218
    v_rcp_f32 v219, v219
    v_pk_mul_f32 v[96:97], v[96:97], v[212:213]
    v_pk_mul_f32 v[98:99], v[98:99], v[214:215]
    v_pk_mul_f32 v[100:101], v[100:101], v[216:217]
    v_pk_mul_f32 v[102:103], v[102:103], v[218:219]
    v_pk_mul_f32 v[212:213], v[104:105], v[104:105]
    v_pk_mul_f32 v[214:215], v[106:107], v[106:107]
    v_pk_mul_f32 v[216:217], v[108:109], v[108:109]
    v_pk_mul_f32 v[218:219], v[110:111], v[110:111]
    v_pk_fma_f32 v[212:213], v[212:213], v[242:243], v[240:241]
    v_pk_fma_f32 v[214:215], v[214:215], v[242:243], v[240:241]
    v_pk_fma_f32 v[216:217], v[216:217], v[242:243], v[240:241]
    v_pk_fma_f32 v[218:219], v[218:219], v[242:243], v[240:241]
    v_pk_mul_f32 v[212:213], v[212:213], v[104:105]
    v_pk_mul_f32 v[214:215], v[214:215], v[106:107]
    v_pk_mul_f32 v[216:217], v[216:217], v[108:109]
    v_pk_mul_f32 v[218:219], v[218:219], v[110:111]
    v_exp_f32 v212, v212
    v_exp_f32 v213, v213
    v_exp_f32 v214, v214
    v_exp_f32 v215, v215
    v_exp_f32 v216, v216
    v_exp_f32 v217, v217
    v_exp_f32 v218, v218
    v_exp_f32 v219, v219
    v_pk_add_f32 v[212:213], v[212:213], v[244:245]
    v_pk_add_f32 v[214:215], v[214:215], v[244:245]
    v_pk_add_f32 v[216:217], v[216:217], v[244:245]
    v_pk_add_f32 v[218:219], v[218:219], v[244:245]
    v_rcp_f32 v212, v212
    v_rcp_f32 v213, v213
    v_rcp_f32 v214, v214
    v_rcp_f32 v215, v215
    v_rcp_f32 v216, v216
    v_rcp_f32 v217, v217
    v_rcp_f32 v218, v218
    v_rcp_f32 v219, v219
    v_pk_mul_f32 v[104:105], v[104:105], v[212:213]
    v_pk_mul_f32 v[106:107], v[106:107], v[214:215]
    v_pk_mul_f32 v[108:109], v[108:109], v[216:217]
    v_pk_mul_f32 v[110:111], v[110:111], v[218:219]
    v_pk_mul_f32 v[212:213], v[112:113], v[112:113]
    v_pk_mul_f32 v[214:215], v[114:115], v[114:115]
    v_pk_mul_f32 v[216:217], v[116:117], v[116:117]
    v_pk_mul_f32 v[218:219], v[118:119], v[118:119]
    v_pk_fma_f32 v[212:213], v[212:213], v[242:243], v[240:241]
    v_pk_fma_f32 v[214:215], v[214:215], v[242:243], v[240:241]
    v_pk_fma_f32 v[216:217], v[216:217], v[242:243], v[240:241]
    v_pk_fma_f32 v[218:219], v[218:219], v[242:243], v[240:241]
    v_pk_mul_f32 v[212:213], v[212:213], v[112:113]
    v_pk_mul_f32 v[214:215], v[214:215], v[114:115]
    v_pk_mul_f32 v[216:217], v[216:217], v[116:117]
    v_pk_mul_f32 v[218:219], v[218:219], v[118:119]
    v_exp_f32 v212, v212
    v_exp_f32 v213, v213
    v_exp_f32 v214, v214
    v_exp_f32 v215, v215
    v_exp_f32 v216, v216
    v_exp_f32 v217, v217
    v_exp_f32 v218, v218
    v_exp_f32 v219, v219
    v_pk_add_f32 v[212:213], v[212:213], v[244:245]
    v_pk_add_f32 v[214:215], v[214:215], v[244:245]
    v_pk_add_f32 v[216:217], v[216:217], v[244:245]
    v_pk_add_f32 v[218:219], v[218:219], v[244:245]
    v_rcp_f32 v212, v212
    v_rcp_f32 v213, v213
    v_rcp_f32 v214, v214
    v_rcp_f32 v215, v215
    v_rcp_f32 v216, v216
    v_rcp_f32 v217, v217
    v_rcp_f32 v218, v218
    v_rcp_f32 v219, v219
    v_pk_mul_f32 v[112:113], v[112:113], v[212:213]
    v_pk_mul_f32 v[114:115], v[114:115], v[214:215]
    v_pk_mul_f32 v[116:117], v[116:117], v[216:217]
    v_pk_mul_f32 v[118:119], v[118:119], v[218:219]
    v_pk_mul_f32 v[212:213], v[120:121], v[120:121]
    v_pk_mul_f32 v[214:215], v[122:123], v[122:123]
    v_pk_mul_f32 v[216:217], v[124:125], v[124:125]
    v_pk_mul_f32 v[218:219], v[126:127], v[126:127]
    v_pk_fma_f32 v[212:213], v[212:213], v[242:243], v[240:241]
    v_pk_fma_f32 v[214:215], v[214:215], v[242:243], v[240:241]
    v_pk_fma_f32 v[216:217], v[216:217], v[242:243], v[240:241]
    v_pk_fma_f32 v[218:219], v[218:219], v[242:243], v[240:241]
    v_pk_mul_f32 v[212:213], v[212:213], v[120:121]
    v_pk_mul_f32 v[214:215], v[214:215], v[122:123]
    v_pk_mul_f32 v[216:217], v[216:217], v[124:125]
    v_pk_mul_f32 v[218:219], v[218:219], v[126:127]
    v_exp_f32 v212, v212
    v_exp_f32 v213, v213
    v_exp_f32 v214, v214
    v_exp_f32 v215, v215
    v_exp_f32 v216, v216
    v_exp_f32 v217, v217
    v_exp_f32 v218, v218
    v_exp_f32 v219, v219
    v_pk_add_f32 v[212:213], v[212:213], v[244:245]
    v_pk_add_f32 v[214:215], v[214:215], v[244:245]
    v_pk_add_f32 v[216:217], v[216:217], v[244:245]
    v_pk_add_f32 v[218:219], v[218:219], v[244:245]
    v_rcp_f32 v212, v212
    v_rcp_f32 v213, v213
    v_rcp_f32 v214, v214
    v_rcp_f32 v215, v215
    v_rcp_f32 v216, v216
    v_rcp_f32 v217, v217
    v_rcp_f32 v218, v218
    v_rcp_f32 v219, v219
    v_pk_mul_f32 v[120:121], v[120:121], v[212:213]
    v_pk_mul_f32 v[122:123], v[122:123], v[214:215]
    v_pk_mul_f32 v[124:125], v[124:125], v[216:217]
    v_pk_mul_f32 v[126:127], v[126:127], v[218:219]
    v_pk_mul_f32 v[212:213], v[128:129], v[128:129]
    v_pk_mul_f32 v[214:215], v[130:131], v[130:131]
    v_pk_mul_f32 v[216:217], v[132:133], v[132:133]
    v_pk_mul_f32 v[218:219], v[134:135], v[134:135]
    v_pk_fma_f32 v[212:213], v[212:213], v[242:243], v[240:241]
    v_pk_fma_f32 v[214:215], v[214:215], v[242:243], v[240:241]
    v_pk_fma_f32 v[216:217], v[216:217], v[242:243], v[240:241]
    v_pk_fma_f32 v[218:219], v[218:219], v[242:243], v[240:241]
    v_pk_mul_f32 v[212:213], v[212:213], v[128:129]
    v_pk_mul_f32 v[214:215], v[214:215], v[130:131]
    v_pk_mul_f32 v[216:217], v[216:217], v[132:133]
    v_pk_mul_f32 v[218:219], v[218:219], v[134:135]
    v_exp_f32 v212, v212
    v_exp_f32 v213, v213
    v_exp_f32 v214, v214
    v_exp_f32 v215, v215
    v_exp_f32 v216, v216
    v_exp_f32 v217, v217
    v_exp_f32 v218, v218
    v_exp_f32 v219, v219
    v_pk_add_f32 v[212:213], v[212:213], v[244:245]
    v_pk_add_f32 v[214:215], v[214:215], v[244:245]
    v_pk_add_f32 v[216:217], v[216:217], v[244:245]
    v_pk_add_f32 v[218:219], v[218:219], v[244:245]
    v_rcp_f32 v212, v212
    v_rcp_f32 v213, v213
    v_rcp_f32 v214, v214
    v_rcp_f32 v215, v215
    v_rcp_f32 v216, v216
    v_rcp_f32 v217, v217
    v_rcp_f32 v218, v218
    v_rcp_f32 v219, v219
    v_pk_mul_f32 v[128:129], v[128:129], v[212:213]
    v_pk_mul_f32 v[130:131], v[130:131], v[214:215]
    v_pk_mul_f32 v[132:133], v[132:133], v[216:217]
    v_pk_mul_f32 v[134:135], v[134:135], v[218:219]
    v_pk_mul_f32 v[212:213], v[136:137], v[136:137]
    v_pk_mul_f32 v[214:215], v[138:139], v[138:139]
    v_pk_mul_f32 v[216:217], v[140:141], v[140:141]
    v_pk_mul_f32 v[218:219], v[142:143], v[142:143]
    v_pk_fma_f32 v[212:213], v[212:213], v[242:243], v[240:241]
    v_pk_fma_f32 v[214:215], v[214:215], v[242:243], v[240:241]
    v_pk_fma_f32 v[216:217], v[216:217], v[242:243], v[240:241]
    v_pk_fma_f32 v[218:219], v[218:219], v[242:243], v[240:241]
    v_pk_mul_f32 v[212:213], v[212:213], v[136:137]
    v_pk_mul_f32 v[214:215], v[214:215], v[138:139]
    v_pk_mul_f32 v[216:217], v[216:217], v[140:141]
    v_pk_mul_f32 v[218:219], v[218:219], v[142:143]
    v_exp_f32 v212, v212
    v_exp_f32 v213, v213
    v_exp_f32 v214, v214
    v_exp_f32 v215, v215
    v_exp_f32 v216, v216
    v_exp_f32 v217, v217
    v_exp_f32 v218, v218
    v_exp_f32 v219, v219
    v_pk_add_f32 v[212:213], v[212:213], v[244:245]
    v_pk_add_f32 v[214:215], v[214:215], v[244:245]
    v_pk_add_f32 v[216:217], v[216:217], v[244:245]
    v_pk_add_f32 v[218:219], v[218:219], v[244:245]
    v_rcp_f32 v212, v212
    v_rcp_f32 v213, v213
    v_rcp_f32 v214, v214
    v_rcp_f32 v215, v215
    v_rcp_f32 v216, v216
    v_rcp_f32 v217, v217
    v_rcp_f32 v218, v218
    v_rcp_f32 v219, v219
    v_pk_mul_f32 v[136:137], v[136:137], v[212:213]
    v_pk_mul_f32 v[138:139], v[138:139], v[214:215]
    v_pk_mul_f32 v[140:141], v[140:141], v[216:217]
    v_pk_mul_f32 v[142:143], v[142:143], v[218:219]
    v_pk_mul_f32 v[212:213], v[144:145], v[144:145]
    v_pk_mul_f32 v[214:215], v[146:147], v[146:147]
    v_pk_mul_f32 v[216:217], v[148:149], v[148:149]
    v_pk_mul_f32 v[218:219], v[150:151], v[150:151]
    v_pk_fma_f32 v[212:213], v[212:213], v[242:243], v[240:241]
    v_pk_fma_f32 v[214:215], v[214:215], v[242:243], v[240:241]
    v_pk_fma_f32 v[216:217], v[216:217], v[242:243], v[240:241]
    v_pk_fma_f32 v[218:219], v[218:219], v[242:243], v[240:241]
    v_pk_mul_f32 v[212:213], v[212:213], v[144:145]
    v_pk_mul_f32 v[214:215], v[214:215], v[146:147]
    v_pk_mul_f32 v[216:217], v[216:217], v[148:149]
    v_pk_mul_f32 v[218:219], v[218:219], v[150:151]
    v_exp_f32 v212, v212
    v_exp_f32 v213, v213
    v_exp_f32 v214, v214
    v_exp_f32 v215, v215
    v_exp_f32 v216, v216
    v_exp_f32 v217, v217
    v_exp_f32 v218, v218
    v_exp_f32 v219, v219
    v_pk_add_f32 v[212:213], v[212:213], v[244:245]
    v_pk_add_f32 v[214:215], v[214:215], v[244:245]
    v_pk_add_f32 v[216:217], v[216:217], v[244:245]
    v_pk_add_f32 v[218:219], v[218:219], v[244:245]
    v_rcp_f32 v212, v212
    v_rcp_f32 v213, v213
    v_rcp_f32 v214, v214
    v_rcp_f32 v215, v215
    v_rcp_f32 v216, v216
    v_rcp_f32 v217, v217
    v_rcp_f32 v218, v218
    v_rcp_f32 v219, v219
    v_pk_mul_f32 v[144:145], v[144:145], v[212:213]
    v_pk_mul_f32 v[146:147], v[146:147], v[214:215]
    v_pk_mul_f32 v[148:149], v[148:149], v[216:217]
    v_pk_mul_f32 v[150:151], v[150:151], v[218:219]
    s_waitcnt lgkmcnt(0)
    s_barrier
    ds_read_b128 v[152:155], v236 offset:0
    ds_read_b128 v[156:159], v236 offset:2048
    ds_read_b128 v[168:171], v238 offset:0
    ds_read_b128 v[172:175], v238 offset:1024
    ds_read_b128 v[176:179], v238 offset:2048
    ds_read_b128 v[180:183], v238 offset:3072
    ds_read_b128 v[184:187], v238 offset:4096
    ds_read_b128 v[188:191], v238 offset:5120
    ds_read_b128 v[192:195], v238 offset:6144
    ds_read_b128 v[196:199], v238 offset:7168
    ds_read_b128 v[200:203], v238 offset:8192
    s_waitcnt lgkmcnt(8)
    v_mfma_f32_16x16x32_bf16 v[8:11], v[168:171], v[152:155], v[204:207]
    ds_read_b128 v[160:163], v237 offset:0
    v_mfma_f32_16x16x32_bf16 v[12:15], v[168:171], v[156:159], v[208:211]
    ds_read_b128 v[164:167], v237 offset:2048
    s_waitcnt lgkmcnt(9)
    v_mfma_f32_16x16x32_bf16 v[16:19], v[172:175], v[152:155], v[204:207]
    ds_read_b128 v[168:171], v238 offset:9216
    v_mfma_f32_16x16x32_bf16 v[20:23], v[172:175], v[156:159], v[208:211]
    ds_read_b128 v[172:175], v238 offset:10240
    s_waitcnt lgkmcnt(10)
    v_mfma_f32_16x16x32_bf16 v[24:27], v[176:179], v[152:155], v[204:207]
    v_mfma_f32_16x16x32_bf16 v[28:31], v[176:179], v[156:159], v[208:211]
    ds_read_b128 v[176:179], v238 offset:11264
    s_waitcnt lgkmcnt(10)
    v_mfma_f32_16x16x32_bf16 v[32:35], v[180:183], v[152:155], v[204:207]
    v_mfma_f32_16x16x32_bf16 v[36:39], v[180:183], v[156:159], v[208:211]
    ds_read_b128 v[180:183], v238 offset:12288
    s_waitcnt lgkmcnt(10)
    v_mfma_f32_16x16x32_bf16 v[40:43], v[184:187], v[152:155], v[204:207]
    v_mfma_f32_16x16x32_bf16 v[44:47], v[184:187], v[156:159], v[208:211]
    ds_read_b128 v[184:187], v238 offset:13312
    s_waitcnt lgkmcnt(10)
    v_mfma_f32_16x16x32_bf16 v[48:51], v[188:191], v[152:155], v[204:207]
    v_mfma_f32_16x16x32_bf16 v[52:55], v[188:191], v[156:159], v[208:211]
    ds_read_b128 v[188:191], v238 offset:14336
    s_waitcnt lgkmcnt(10)
    v_mfma_f32_16x16x32_bf16 v[56:59], v[192:195], v[152:155], v[204:207]
    v_mfma_f32_16x16x32_bf16 v[60:63], v[192:195], v[156:159], v[208:211]
    ds_read_b128 v[192:195], v238 offset:15360
    s_waitcnt lgkmcnt(10)
    v_mfma_f32_16x16x32_bf16 v[64:67], v[196:199], v[152:155], v[204:207]
    v_mfma_f32_16x16x32_bf16 v[68:71], v[196:199], v[156:159], v[208:211]
    ds_read_b128 v[196:199], v238 offset:16384
    s_waitcnt lgkmcnt(10)
    v_mfma_f32_16x16x32_bf16 v[72:75], v[200:203], v[152:155], v[204:207]
    v_mfma_f32_16x16x32_bf16 v[76:79], v[200:203], v[156:159], v[208:211]
    ds_read_b128 v[200:203], v238 offset:17408
    s_waitcnt lgkmcnt(8)
    v_mfma_f32_16x16x32_bf16 v[8:11], v[168:171], v[160:163], v[8:11]
    s_add_u32 s61, s61, 1
    s_and_b32 s61, s61, 3
    s_cselect_b32 s62, 34816, s65
    v_mfma_f32_16x16x32_bf16 v[12:15], v[168:171], v[164:167], v[12:15]
    v_add_u32 v236, s62, v236
    s_waitcnt lgkmcnt(7)
    v_mfma_f32_16x16x32_bf16 v[16:19], v[172:175], v[160:163], v[16:19]
    v_add_u32 v237, s62, v237
    v_mfma_f32_16x16x32_bf16 v[20:23], v[172:175], v[164:167], v[20:23]
    v_add_u32 v238, s62, v238
    s_waitcnt lgkmcnt(6)
    v_mfma_f32_16x16x32_bf16 v[24:27], v[176:179], v[160:163], v[24:27]
    v_add_u32 v239, s62, v239
    v_mfma_f32_16x16x32_bf16 v[28:31], v[176:179], v[164:167], v[28:31]
    s_waitcnt lgkmcnt(0)
    s_barrier
    v_mfma_f32_16x16x32_bf16 v[32:35], v[180:183], v[160:163], v[32:35]
    ds_read_b128 v[152:155], v236 offset:0
    v_mfma_f32_16x16x32_bf16 v[36:39], v[180:183], v[164:167], v[36:39]
    ds_read_b128 v[156:159], v236 offset:2048
    v_mfma_f32_16x16x32_bf16 v[40:43], v[184:187], v[160:163], v[40:43]
    ds_read_b128 v[168:171], v238 offset:0
    v_mfma_f32_16x16x32_bf16 v[44:47], v[184:187], v[164:167], v[44:47]
    ds_read_b128 v[172:175], v238 offset:1024
    v_mfma_f32_16x16x32_bf16 v[48:51], v[188:191], v[160:163], v[48:51]
    ds_read_b128 v[176:179], v238 offset:2048
    v_mfma_f32_16x16x32_bf16 v[52:55], v[188:191], v[164:167], v[52:55]
    ds_read_b128 v[180:183], v238 offset:3072
    v_mfma_f32_16x16x32_bf16 v[56:59], v[192:195], v[160:163], v[56:59]
    ds_read_b128 v[184:187], v238 offset:4096
    v_mfma_f32_16x16x32_bf16 v[60:63], v[192:195], v[164:167], v[60:63]
    ds_read_b128 v[188:191], v238 offset:5120
    v_mfma_f32_16x16x32_bf16 v[64:67], v[196:199], v[160:163], v[64:67]
    ds_read_b128 v[192:195], v238 offset:6144
    v_mfma_f32_16x16x32_bf16 v[68:71], v[196:199], v[164:167], v[68:71]
    ds_read_b128 v[196:199], v238 offset:7168
    v_mfma_f32_16x16x32_bf16 v[72:75], v[200:203], v[160:163], v[72:75]
    v_mfma_f32_16x16x32_bf16 v[76:79], v[200:203], v[164:167], v[76:79]
    ds_read_b128 v[200:203], v238 offset:8192
    s_mov_b32 s69, 29
L_cC:
    s_waitcnt lgkmcnt(8)
    v_mfma_f32_16x16x32_bf16 v[8:11], v[168:171], v[152:155], v[8:11]
    ds_read_b128 v[160:163], v237 offset:0
    v_mfma_f32_16x16x32_bf16 v[12:15], v[168:171], v[156:159], v[12:15]
    ds_read_b128 v[164:167], v237 offset:2048
    s_waitcnt lgkmcnt(9)
    v_mfma_f32_16x16x32_bf16 v[16:19], v[172:175], v[152:155], v[16:19]
    ds_read_b128 v[168:171], v238 offset:9216
    v_mfma_f32_16x16x32_bf16 v[20:23], v[172:175], v[156:159], v[20:23]
    ds_read_b128 v[172:175], v238 offset:10240
    s_waitcnt lgkmcnt(10)
    v_mfma_f32_16x16x32_bf16 v[24:27], v[176:179], v[152:155], v[24:27]
    v_mfma_f32_16x16x32_bf16 v[28:31], v[176:179], v[156:159], v[28:31]
    ds_read_b128 v[176:179], v238 offset:11264
    s_waitcnt lgkmcnt(10)
    v_mfma_f32_16x16x32_bf16 v[32:35], v[180:183], v[152:155], v[32:35]
    v_mfma_f32_16x16x32_bf16 v[36:39], v[180:183], v[156:159], v[36:39]
    ds_read_b128 v[180:183], v238 offset:12288
    s_waitcnt lgkmcnt(10)
    v_mfma_f32_16x16x32_bf16 v[40:43], v[184:187], v[152:155], v[40:43]
    v_mfma_f32_16x16x32_bf16 v[44:47], v[184:187], v[156:159], v[44:47]
    ds_read_b128 v[184:187], v238 offset:13312
    s_waitcnt lgkmcnt(10)
    v_mfma_f32_16x16x32_bf16 v[48:51], v[188:191], v[152:155], v[48:51]
    v_mfma_f32_16x16x32_bf16 v[52:55], v[188:191], v[156:159], v[52:55]
    ds_read_b128 v[188:191], v238 offset:14336
    s_waitcnt lgkmcnt(10)
    v_mfma_f32_16x16x32_bf16 v[56:59], v[192:195], v[152:155], v[56:59]
    v_mfma_f32_16x16x32_bf16 v[60:63], v[192:195], v[156:159], v[60:63]
    ds_read_b128 v[192:195], v238 offset:15360
    s_waitcnt lgkmcnt(10)
    v_mfma_f32_16x16x32_bf16 v[64:67], v[196:199], v[152:155], v[64:67]
    v_mfma_f32_16x16x32_bf16 v[68:71], v[196:199], v[156:159], v[68:71]
    ds_read_b128 v[196:199], v238 offset:16384
    s_waitcnt lgkmcnt(10)
    v_mfma_f32_16x16x32_bf16 v[72:75], v[200:203], v[152:155], v[72:75]
    v_mfma_f32_16x16x32_bf16 v[76:79], v[200:203], v[156:159], v[76:79]
    ds_read_b128 v[200:203], v238 offset:17408
    s_sub_u32 s69, s69, 1
    s_cmp_eq_u32 s69, 0
    s_cbranch_scc1 L_cC_exit
    s_waitcnt lgkmcnt(8)
    v_mfma_f32_16x16x32_bf16 v[8:11], v[168:171], v[160:163], v[8:11]
    s_add_u32 s61, s61, 1
    s_and_b32 s61, s61, 3
    s_cselect_b32 s62, 34816, s65
    v_mfma_f32_16x16x32_bf16 v[12:15], v[168:171], v[164:167], v[12:15]
    v_add_u32 v236, s62, v236
    s_waitcnt lgkmcnt(7)
    v_mfma_f32_16x16x32_bf16 v[16:19], v[172:175], v[160:163], v[16:19]
    v_add_u32 v237, s62, v237
    v_mfma_f32_16x16x32_bf16 v[20:23], v[172:175], v[164:167], v[20:23]
    v_add_u32 v238, s62, v238
    s_waitcnt lgkmcnt(6)
    v_mfma_f32_16x16x32_bf16 v[24:27], v[176:179], v[160:163], v[24:27]
    v_add_u32 v239, s62, v239
    v_mfma_f32_16x16x32_bf16 v[28:31], v[176:179], v[164:167], v[28:31]
    s_waitcnt lgkmcnt(0)
    s_barrier
    v_mfma_f32_16x16x32_bf16 v[32:35], v[180:183], v[160:163], v[32:35]
    ds_read_b128 v[152:155], v236 offset:0
    v_mfma_f32_16x16x32_bf16 v[36:39], v[180:183], v[164:167], v[36:39]
    ds_read_b128 v[156:159], v236 offset:2048
    v_mfma_f32_16x16x32_bf16 v[40:43], v[184:187], v[160:163], v[40:43]
    ds_read_b128 v[168:171], v238 offset:0
    v_mfma_f32_16x16x32_bf16 v[44:47], v[184:187], v[164:167], v[44:47]
    ds_read_b128 v[172:175], v238 offset:1024
    v_mfma_f32_16x16x32_bf16 v[48:51], v[188:191], v[160:163], v[48:51]
    ds_read_b128 v[176:179], v238 offset:2048
    v_mfma_f32_16x16x32_bf16 v[52:55], v[188:191], v[164:167], v[52:55]
    ds_read_b128 v[180:183], v238 offset:3072
    v_mfma_f32_16x16x32_bf16 v[56:59], v[192:195], v[160:163], v[56:59]
    ds_read_b128 v[184:187], v238 offset:4096
    v_mfma_f32_16x16x32_bf16 v[60:63], v[192:195], v[164:167], v[60:63]
    ds_read_b128 v[188:191], v238 offset:5120
    v_mfma_f32_16x16x32_bf16 v[64:67], v[196:199], v[160:163], v[64:67]
    ds_read_b128 v[192:195], v238 offset:6144
    v_mfma_f32_16x16x32_bf16 v[68:71], v[196:199], v[164:167], v[68:71]
    ds_read_b128 v[196:199], v238 offset:7168
    v_mfma_f32_16x16x32_bf16 v[72:75], v[200:203], v[160:163], v[72:75]
    v_mfma_f32_16x16x32_bf16 v[76:79], v[200:203], v[164:167], v[76:79]
    ds_read_b128 v[200:203], v238 offset:8192
    s_branch L_cC
L_cC_exit:
    s_waitcnt lgkmcnt(8)
    v_mfma_f32_16x16x32_bf16 v[8:11], v[168:171], v[160:163], v[8:11]
    s_add_u32 s61, s61, 1
    s_and_b32 s61, s61, 3
    s_cselect_b32 s62, 34816, s65
    v_mfma_f32_16x16x32_bf16 v[12:15], v[168:171], v[164:167], v[12:15]
    v_add_u32 v236, s62, v236
    s_waitcnt lgkmcnt(7)
    v_mfma_f32_16x16x32_bf16 v[16:19], v[172:175], v[160:163], v[16:19]
    v_add_u32 v237, s62, v237
    v_mfma_f32_16x16x32_bf16 v[20:23], v[172:175], v[164:167], v[20:23]
    v_add_u32 v238, s62, v238
    s_waitcnt lgkmcnt(6)
    v_mfma_f32_16x16x32_bf16 v[24:27], v[176:179], v[160:163], v[24:27]
    v_add_u32 v239, s62, v239
    v_mfma_f32_16x16x32_bf16 v[28:31], v[176:179], v[164:167], v[28:31]
    s_lshl_b32 s57, s53, 2
    s_add_u32 s57, s57, s56
    s_lshl_b32 s59, s57, 7
    s_lshl_b32 s58, s54, 2
    s_add_u32 s59, s59, s58
    s_add_u32 s59, s59, 22609920
    s_mul_i32 s57, s57, 144
    s_mul_i32 s58, s54, 9
    s_add_u32 s57, s57, s58
    s_lshl_b32 s57, s57, 10
    s_add_u32 s57, s57, 9437184
    s_waitcnt lgkmcnt(0)
    s_barrier
    v_mfma_f32_16x16x32_bf16 v[32:35], v[180:183], v[160:163], v[32:35]
    ds_read_b128 v[152:155], v236 offset:0
    ds_read_b128 v[156:159], v236 offset:2048
    v_mfma_f32_16x16x32_bf16 v[36:39], v[180:183], v[164:167], v[36:39]
    ds_read_b128 v[168:171], v238 offset:0
    ds_read_b128 v[204:207], v237 offset:0
    v_mfma_f32_16x16x32_bf16 v[40:43], v[184:187], v[160:163], v[40:43]
    ds_read_b128 v[208:211], v237 offset:2048
    ds_read_b128 v[172:175], v238 offset:9216
    v_mfma_f32_16x16x32_bf16 v[44:47], v[184:187], v[164:167], v[44:47]
    ds_read_b128 v[212:215], v236 offset:34816
    ds_read_b128 v[216:219], v236 offset:36864
    v_mfma_f32_16x16x32_bf16 v[48:51], v[188:191], v[160:163], v[48:51]
    ds_read_b128 v[176:179], v238 offset:34816
    v_mfma_f32_16x16x32_bf16 v[52:55], v[188:191], v[164:167], v[52:55]
    ds_read_b128 v[220:223], v237 offset:34816
    v_mfma_f32_16x16x32_bf16 v[56:59], v[192:195], v[160:163], v[56:59]
    ds_read_b128 v[224:227], v237 offset:36864
    v_mfma_f32_16x16x32_bf16 v[60:63], v[192:195], v[164:167], v[60:63]
    ds_read_b128 v[180:183], v238 offset:44032
    v_mfma_f32_16x16x32_bf16 v[64:67], v[196:199], v[160:163], v[64:67]
    ds_read_b128 v[184:187], v238 offset:1024
    v_mfma_f32_16x16x32_bf16 v[68:71], v[196:199], v[164:167], v[68:71]
    ds_read_b128 v[188:191], v238 offset:10240
    v_mfma_f32_16x16x32_bf16 v[72:75], v[200:203], v[160:163], v[72:75]
    ds_read_b128 v[192:195], v238 offset:35840
    v_mfma_f32_16x16x32_bf16 v[76:79], v[200:203], v[164:167], v[76:79]
    ds_read_b128 v[196:199], v238 offset:45056
    ds_read_b128 v[200:203], v238 offset:2048
    s_waitcnt lgkmcnt(14)
    v_mfma_f32_16x16x32_bf16 v[8:11], v[168:171], v[152:155], v[8:11]
    v_mfma_f32_16x16x32_bf16 v[12:15], v[168:171], v[156:159], v[12:15]
    ds_read_b128 v[168:171], v238 offset:11264
    s_waitcnt lgkmcnt(12)
    v_mfma_f32_16x16x32_bf16 v[8:11], v[172:175], v[204:207], v[8:11]
    v_mfma_f32_16x16x32_bf16 v[12:15], v[172:175], v[208:211], v[12:15]
    ds_read_b128 v[172:175], v238 offset:36864
    s_waitcnt lgkmcnt(10)
    v_mfma_f32_16x16x32_bf16 v[8:11], v[176:179], v[212:215], v[8:11]
    v_mfma_f32_16x16x32_bf16 v[12:15], v[176:179], v[216:219], v[12:15]
    ds_read_b128 v[176:179], v238 offset:46080
    s_waitcnt lgkmcnt(8)
    v_mfma_f32_16x16x32_bf16 v[8:11], v[180:183], v[220:223], v[8:11]
    v_mfma_f32_16x16x32_bf16 v[12:15], v[180:183], v[224:227], v[12:15]
    ds_read_b128 v[180:183], v238 offset:3072
    s_waitcnt lgkmcnt(8)
    v_mfma_f32_16x16x32_bf16 v[16:19], v[184:187], v[152:155], v[16:19]
    v_mfma_f32_16x16x32_bf16 v[20:23], v[184:187], v[156:159], v[20:23]
    ds_read_b128 v[184:187], v238 offset:12288
    s_waitcnt lgkmcnt(8)
    v_mfma_f32_16x16x32_bf16 v[16:19], v[188:191], v[204:207], v[16:19]
    v_mfma_f32_16x16x32_bf16 v[20:23], v[188:191], v[208:211], v[20:23]
    ds_read_b128 v[188:191], v238 offset:37888
    s_waitcnt lgkmcnt(8)
    v_mfma_f32_16x16x32_bf16 v[16:19], v[192:195], v[212:215], v[16:19]
    v_mul_f32 v8, v8, v80
    v_mul_f32 v9, v9, v81
    v_mfma_f32_16x16x32_bf16 v[20:23], v[192:195], v[216:219], v[20:23]
    ds_read_b128 v[192:195], v238 offset:47104
    v_mul_f32 v10, v10, v82
    v_mul_f32 v11, v11, v83
    s_waitcnt lgkmcnt(8)
    v_mfma_f32_16x16x32_bf16 v[16:19], v[196:199], v[220:223], v[16:19]
    v_mul_f32 v12, v12, v84
    v_mul_f32 v13, v13, v85
    v_mfma_f32_16x16x32_bf16 v[20:23], v[196:199], v[224:227], v[20:23]
    ds_read_b128 v[196:199], v238 offset:4096
    v_mul_f32 v14, v14, v86
    v_mul_f32 v15, v15, v87
    s_waitcnt lgkmcnt(8)
    v_mfma_f32_16x16x32_bf16 v[24:27], v[200:203], v[152:155], v[24:27]
    v_cvt_pk_bf16_f32 v80, v8, v9
    v_cvt_pk_bf16_f32 v81, v10, v11
    v_mfma_f32_16x16x32_bf16 v[28:31], v[200:203], v[156:159], v[28:31]
    ds_read_b128 v[200:203], v238 offset:13312
    v_cvt_pk_bf16_f32 v82, v12, v13
    v_cvt_pk_bf16_f32 v83, v14, v15
    s_waitcnt lgkmcnt(8)
    v_mfma_f32_16x16x32_bf16 v[24:27], v[168:171], v[204:207], v[24:27]
    buffer_store_dwordx4 v[80:83], v1, s[32:35], s57 offen offset:0 sc1
    v_mfma_f32_16x16x32_bf16 v[28:31], v[168:171], v[208:211], v[28:31]
    ds_read_b128 v[168:171], v238 offset:38912
    s_waitcnt lgkmcnt(8)
    v_mfma_f32_16x16x32_bf16 v[24:27], v[172:175], v[212:215], v[24:27]
    v_mul_f32 v16, v16, v88
    v_mul_f32 v17, v17, v89
    v_mfma_f32_16x16x32_bf16 v[28:31], v[172:175], v[216:219], v[28:31]
    ds_read_b128 v[172:175], v238 offset:48128
    v_mul_f32 v18, v18, v90
    v_mul_f32 v19, v19, v91
    s_waitcnt lgkmcnt(8)
    v_mfma_f32_16x16x32_bf16 v[24:27], v[176:179], v[220:223], v[24:27]
    v_mul_f32 v20, v20, v92
    v_mul_f32 v21, v21, v93
    v_mfma_f32_16x16x32_bf16 v[28:31], v[176:179], v[224:227], v[28:31]
    ds_read_b128 v[176:179], v238 offset:5120
    v_mul_f32 v22, v22, v94
    v_mul_f32 v23, v23, v95
    s_waitcnt lgkmcnt(8)
    v_mfma_f32_16x16x32_bf16 v[32:35], v[180:183], v[152:155], v[32:35]
    v_cvt_pk_bf16_f32 v88, v16, v17
    v_cvt_pk_bf16_f32 v89, v18, v19
    v_mfma_f32_16x16x32_bf16 v[36:39], v[180:183], v[156:159], v[36:39]
    ds_read_b128 v[180:183], v238 offset:14336
    v_cvt_pk_bf16_f32 v90, v20, v21
    v_cvt_pk_bf16_f32 v91, v22, v23
    s_waitcnt lgkmcnt(8)
    v_mfma_f32_16x16x32_bf16 v[32:35], v[184:187], v[204:207], v[32:35]
    buffer_store_dwordx4 v[88:91], v1, s[32:35], s57 offen offset:1024 sc1
    v_mfma_f32_16x16x32_bf16 v[36:39], v[184:187], v[208:211], v[36:39]
    ds_read_b128 v[184:187], v238 offset:39936
    s_waitcnt lgkmcnt(8)
    v_mfma_f32_16x16x32_bf16 v[32:35], v[188:191], v[212:215], v[32:35]
    v_mul_f32 v24, v24, v96
    v_mul_f32 v25, v25, v97
    v_mfma_f32_16x16x32_bf16 v[36:39], v[188:191], v[216:219], v[36:39]
    ds_read_b128 v[188:191], v238 offset:49152
    v_mul_f32 v26, v26, v98
    v_mul_f32 v27, v27, v99
    s_waitcnt lgkmcnt(8)
    v_mfma_f32_16x16x32_bf16 v[32:35], v[192:195], v[220:223], v[32:35]
    v_mul_f32 v28, v28, v100
    v_mul_f32 v29, v29, v101
    v_mfma_f32_16x16x32_bf16 v[36:39], v[192:195], v[224:227], v[36:39]
    ds_read_b128 v[192:195], v238 offset:6144
    v_mul_f32 v30, v30, v102
    v_mul_f32 v31, v31, v103
    s_waitcnt lgkmcnt(8)
    v_mfma_f32_16x16x32_bf16 v[40:43], v[196:199], v[152:155], v[40:43]
    v_cvt_pk_bf16_f32 v96, v24, v25
    v_cvt_pk_bf16_f32 v97, v26, v27
    v_mfma_f32_16x16x32_bf16 v[44:47], v[196:199], v[156:159], v[44:47]
    ds_read_b128 v[196:199], v238 offset:15360
    v_cvt_pk_bf16_f32 v98, v28, v29
    v_cvt_pk_bf16_f32 v99, v30, v31
    s_waitcnt lgkmcnt(8)
    v_mfma_f32_16x16x32_bf16 v[40:43], v[200:203], v[204:207], v[40:43]
    buffer_store_dwordx4 v[96:99], v1, s[32:35], s57 offen offset:2048 sc1
    v_mfma_f32_16x16x32_bf16 v[44:47], v[200:203], v[208:211], v[44:47]
    ds_read_b128 v[200:203], v238 offset:40960
    s_waitcnt lgkmcnt(8)
    v_mfma_f32_16x16x32_bf16 v[40:43], v[168:171], v[212:215], v[40:43]
    v_mul_f32 v32, v32, v104
    v_mul_f32 v33, v33, v105
    v_mfma_f32_16x16x32_bf16 v[44:47], v[168:171], v[216:219], v[44:47]
    ds_read_b128 v[168:171], v238 offset:50176
    v_mul_f32 v34, v34, v106
    v_mul_f32 v35, v35, v107
    s_waitcnt lgkmcnt(8)
    v_mfma_f32_16x16x32_bf16 v[40:43], v[172:175], v[220:223], v[40:43]
    v_mul_f32 v36, v36, v108
    v_mul_f32 v37, v37, v109
    v_mfma_f32_16x16x32_bf16 v[44:47], v[172:175], v[224:227], v[44:47]
    ds_read_b128 v[172:175], v238 offset:7168
    v_mul_f32 v38, v38, v110
    v_mul_f32 v39, v39, v111
    s_waitcnt lgkmcnt(8)
    v_mfma_f32_16x16x32_bf16 v[48:51], v[176:179], v[152:155], v[48:51]
    v_cvt_pk_bf16_f32 v104, v32, v33
    v_cvt_pk_bf16_f32 v105, v34, v35
    v_mfma_f32_16x16x32_bf16 v[52:55], v[176:179], v[156:159], v[52:55]
    ds_read_b128 v[176:179], v238 offset:16384
    v_cvt_pk_bf16_f32 v106, v36, v37
    v_cvt_pk_bf16_f32 v107, v38, v39
    s_waitcnt lgkmcnt(8)
    v_mfma_f32_16x16x32_bf16 v[48:51], v[180:183], v[204:207], v[48:51]
    buffer_store_dwordx4 v[104:107], v1, s[32:35], s57 offen offset:3072 sc1
    v_mfma_f32_16x16x32_bf16 v[52:55], v[180:183], v[208:211], v[52:55]
    ds_read_b128 v[180:183], v238 offset:41984
    s_waitcnt lgkmcnt(8)
    v_mfma_f32_16x16x32_bf16 v[48:51], v[184:187], v[212:215], v[48:51]
    v_mul_f32 v40, v40, v112
    v_mul_f32 v41, v41, v113
    v_mfma_f32_16x16x32_bf16 v[52:55], v[184:187], v[216:219], v[52:55]
    ds_read_b128 v[184:187], v238 offset:51200
    v_mul_f32 v42, v42, v114
    v_mul_f32 v43, v43, v115
    s_waitcnt lgkmcnt(8)
    v_mfma_f32_16x16x32_bf16 v[48:51], v[188:191], v[220:223], v[48:51]
    v_mul_f32 v44, v44, v116
    v_mul_f32 v45, v45, v117
    v_mfma_f32_16x16x32_bf16 v[52:55], v[188:191], v[224:227], v[52:55]
    ds_read_b128 v[188:191], v238 offset:8192
    v_mul_f32 v46, v46, v118
    v_mul_f32 v47, v47, v119
    s_waitcnt lgkmcnt(8)
    v_mfma_f32_16x16x32_bf16 v[56:59], v[192:195], v[152:155], v[56:59]
    v_cvt_pk_bf16_f32 v112, v40, v41
    v_cvt_pk_bf16_f32 v113, v42, v43
    v_mfma_f32_16x16x32_bf16 v[60:63], v[192:195], v[156:159], v[60:63]
    ds_read_b128 v[192:195], v238 offset:17408
    v_cvt_pk_bf16_f32 v114, v44, v45
    v_cvt_pk_bf16_f32 v115, v46, v47
    s_waitcnt lgkmcnt(8)
    v_mfma_f32_16x16x32_bf16 v[56:59], v[196:199], v[204:207], v[56:59]
    s_add_u32 s57, s57, 4096
    buffer_store_dwordx4 v[112:115], v1, s[32:35], s57 offen offset:0 sc1
    v_mfma_f32_16x16x32_bf16 v[60:63], v[196:199], v[208:211], v[60:63]
    ds_read_b128 v[196:199], v238 offset:43008
    s_waitcnt lgkmcnt(8)
    v_mfma_f32_16x16x32_bf16 v[56:59], v[200:203], v[212:215], v[56:59]
    v_mul_f32 v48, v48, v120
    v_mul_f32 v49, v49, v121
    v_mfma_f32_16x16x32_bf16 v[60:63], v[200:203], v[216:219], v[60:63]
    ds_read_b128 v[200:203], v238 offset:52224
    v_mul_f32 v50, v50, v122
    v_mul_f32 v51, v51, v123
    s_waitcnt lgkmcnt(8)
    v_mfma_f32_16x16x32_bf16 v[56:59], v[168:171], v[220:223], v[56:59]
    v_mul_f32 v52, v52, v124
    v_mul_f32 v53, v53, v125
    v_mfma_f32_16x16x32_bf16 v[60:63], v[168:171], v[224:227], v[60:63]
    v_mul_f32 v54, v54, v126
    v_mul_f32 v55, v55, v127
    s_waitcnt lgkmcnt(7)
    v_mfma_f32_16x16x32_bf16 v[64:67], v[172:175], v[152:155], v[64:67]
    v_cvt_pk_bf16_f32 v120, v48, v49
    v_cvt_pk_bf16_f32 v121, v50, v51
    v_mfma_f32_16x16x32_bf16 v[68:71], v[172:175], v[156:159], v[68:71]
    v_cvt_pk_bf16_f32 v122, v52, v53
    v_cvt_pk_bf16_f32 v123, v54, v55
    s_waitcnt lgkmcnt(6)
    v_mfma_f32_16x16x32_bf16 v[64:67], v[176:179], v[204:207], v[64:67]
    buffer_store_dwordx4 v[120:123], v1, s[32:35], s57 offen offset:1024 sc1
    v_mfma_f32_16x16x32_bf16 v[68:71], v[176:179], v[208:211], v[68:71]
    s_waitcnt lgkmcnt(5)
    v_mfma_f32_16x16x32_bf16 v[64:67], v[180:183], v[212:215], v[64:67]
    v_mul_f32 v56, v56, v128
    v_mul_f32 v57, v57, v129
    v_mfma_f32_16x16x32_bf16 v[68:71], v[180:183], v[216:219], v[68:71]
    v_mul_f32 v58, v58, v130
    v_mul_f32 v59, v59, v131
    s_waitcnt lgkmcnt(4)
    v_mfma_f32_16x16x32_bf16 v[64:67], v[184:187], v[220:223], v[64:67]
    v_mul_f32 v60, v60, v132
    v_mul_f32 v61, v61, v133
    v_mfma_f32_16x16x32_bf16 v[68:71], v[184:187], v[224:227], v[68:71]
    v_mul_f32 v62, v62, v134
    v_mul_f32 v63, v63, v135
    s_waitcnt lgkmcnt(3)
    v_mfma_f32_16x16x32_bf16 v[72:75], v[188:191], v[152:155], v[72:75]
    v_cvt_pk_bf16_f32 v128, v56, v57
    v_cvt_pk_bf16_f32 v129, v58, v59
    v_mfma_f32_16x16x32_bf16 v[76:79], v[188:191], v[156:159], v[76:79]
    v_cvt_pk_bf16_f32 v130, v60, v61
    v_cvt_pk_bf16_f32 v131, v62, v63
    s_waitcnt lgkmcnt(2)
    v_mfma_f32_16x16x32_bf16 v[72:75], v[192:195], v[204:207], v[72:75]
    buffer_store_dwordx4 v[128:131], v1, s[32:35], s57 offen offset:2048 sc1
    v_mfma_f32_16x16x32_bf16 v[76:79], v[192:195], v[208:211], v[76:79]
    s_waitcnt lgkmcnt(1)
    v_mfma_f32_16x16x32_bf16 v[72:75], v[196:199], v[212:215], v[72:75]
    v_mul_f32 v64, v64, v136
    v_mul_f32 v65, v65, v137
    v_mfma_f32_16x16x32_bf16 v[76:79], v[196:199], v[216:219], v[76:79]
    v_mul_f32 v66, v66, v138
    v_mul_f32 v67, v67, v139
    s_waitcnt lgkmcnt(0)
    v_mfma_f32_16x16x32_bf16 v[72:75], v[200:203], v[220:223], v[72:75]
    v_mul_f32 v68, v68, v140
    v_mul_f32 v69, v69, v141
    v_mfma_f32_16x16x32_bf16 v[76:79], v[200:203], v[224:227], v[76:79]
    v_mul_f32 v70, v70, v142
    v_mul_f32 v71, v71, v143
    v_cvt_pk_bf16_f32 v136, v64, v65
    v_cvt_pk_bf16_f32 v137, v66, v67
    v_cvt_pk_bf16_f32 v138, v68, v69
    v_cvt_pk_bf16_f32 v139, v70, v71
    buffer_store_dwordx4 v[136:139], v1, s[32:35], s57 offen offset:3072 sc1
    s_add_u32 s61, s61, 1
    s_and_b32 s61, s61, 3
    s_cselect_b32 s62, 34816, s65
    v_add_u32 v236, s62, v236
    v_add_u32 v237, s62, v237
    v_add_u32 v238, s62, v238
    v_add_u32 v239, s62, v239
    s_add_u32 s61, s61, 1
    s_and_b32 s61, s61, 3
    s_cselect_b32 s62, 34816, s65
    v_add_u32 v236, s62, v236
    v_add_u32 v237, s62, v237
    v_add_u32 v238, s62, v238
    v_add_u32 v239, s62, v239
    v_pk_mul_f32 v[72:73], v[72:73], v[144:145]
    v_pk_mul_f32 v[74:75], v[74:75], v[146:147]
    v_pk_mul_f32 v[76:77], v[76:77], v[148:149]
    v_pk_mul_f32 v[78:79], v[78:79], v[150:151]
    v_cvt_pk_bf16_f32 v144, v72, v73
    v_cvt_pk_bf16_f32 v145, v74, v75
    v_cvt_pk_bf16_f32 v146, v76, v77
    v_cvt_pk_bf16_f32 v147, v78, v79
    s_add_u32 s57, s57, 4096
    buffer_store_dwordx4 v[144:147], v1, s[32:35], s57 offen offset:0 sc1
    s_waitcnt vmcnt(0)
    v_mov_b32 v246, s66
    v_mov_b32 v247, 0
    s_mov_b64 exec, 1
    buffer_store_dword v246, v247, s[32:35], s59 offen sc1
    s_mov_b64 exec, -1
    s_lshr_b32 s57, s56, 1
    s_and_b32 s58, s56, 1
    s_lshl_b32 s58, s58, 13
    s_lshl_b32 s60, s57, 12
    s_add_u32 s58, s58, s60
    v_add_u32 v240, s58, v1
    s_mul_i32 s58, s57, 9216
    s_add_u32 s58, s58, 65536
    v_add_u32 v241, s58, v1
    v_add_u32 v242, 55296, v241
    v_lshrrev_b32 v248, 4, v0
    v_lshlrev_b32 v248, 7, v248
    v_and_b32 v249, 7, v0
    v_lshl_add_u32 v248, v249, 4, v248
    v_add_u32 v243, s58, v248
    v_add_u32 v244, 55296, v243
    s_barrier
    ds_read_b128 v[80:83], v241 offset:18432
    ds_read_b128 v[84:87], v241 offset:19456
    ds_read_b128 v[88:91], v241 offset:20480
    ds_read_b128 v[92:95], v241 offset:21504
    ds_read_b128 v[96:99], v243 offset:22528
    ds_read_b128 v[100:103], v241 offset:23040
    ds_read_b128 v[104:107], v241 offset:24064
    ds_read_b128 v[108:111], v241 offset:25088
    ds_read_b128 v[112:115], v241 offset:26112
    ds_read_b128 v[116:119], v243 offset:27136
    ds_read_b128 v[120:123], v241 offset:36864
    ds_read_b128 v[124:127], v241 offset:37888
    ds_read_b128 v[128:131], v241 offset:38912
    ds_read_b128 v[132:135], v241 offset:39936
    ds_read_b128 v[136:139], v243 offset:40960
    ds_read_b128 v[140:143], v241 offset:41472
    ds_read_b128 v[144:147], v241 offset:42496
    ds_read_b128 v[148:151], v241 offset:43520
    ds_read_b128 v[152:155], v241 offset:44544
    ds_read_b128 v[156:159], v243 offset:45568
    ds_read_b128 v[160:163], v242 offset:0
    ds_read_b128 v[164:167], v242 offset:1024
    ds_read_b128 v[168:171], v242 offset:2048
    ds_read_b128 v[172:175], v242 offset:3072
    ds_read_b128 v[176:179], v244 offset:4096
    ds_read_b128 v[180:183], v242 offset:4608
    ds_read_b128 v[184:187], v242 offset:5632
    ds_read_b128 v[188:191], v242 offset:6656
    ds_read_b128 v[192:195], v242 offset:7680
    ds_read_b128 v[196:199], v244 offset:8704
    ds_read_b128 v[200:203], v242 offset:18432
    ds_read_b128 v[204:207], v242 offset:19456
    ds_read_b128 v[208:211], v242 offset:20480
    ds_read_b128 v[212:215], v242 offset:21504
    ds_read_b128 v[216:219], v244 offset:22528
    ds_read_b128 v[220:223], v242 offset:23040
    ds_read_b128 v[224:227], v242 offset:24064
    ds_read_b128 v[228:231], v242 offset:25088
    ds_read_b128 v[232:235], v242 offset:26112
    ds_read_b128 v[236:239], v244 offset:27136
    s_waitcnt lgkmcnt(0)
    s_barrier
    v_mov_b32 v8, 0
    v_mov_b32 v9, 0
    v_mov_b32 v10, 0
    v_mov_b32 v11, 0
    v_mov_b32 v12, 0
    v_mov_b32 v13, 0
    v_mov_b32 v14, 0
    v_mov_b32 v15, 0
    v_mov_b32 v16, 0
    v_mov_b32 v17, 0
    v_mov_b32 v18, 0
    v_mov_b32 v19, 0
    v_mov_b32 v20, 0
    v_mov_b32 v21, 0
    v_mov_b32 v22, 0
    v_mov_b32 v23, 0
    v_mov_b32 v24, 0
    v_mov_b32 v25, 0
    v_mov_b32 v26, 0
    v_mov_b32 v27, 0
    v_mov_b32 v28, 0
    v_mov_b32 v29, 0
    v_mov_b32 v30, 0
    v_mov_b32 v31, 0
    v_mov_b32 v32, 0
    v_mov_b32 v33, 0
    v_mov_b32 v34, 0
    v_mov_b32 v35, 0
    v_mov_b32 v36, 0
    v_mov_b32 v37, 0
    v_mov_b32 v38, 0
    v_mov_b32 v39, 0
    v_mov_b32 v40, 0
    v_mov_b32 v41, 0
    v_mov_b32 v42, 0
    v_mov_b32 v43, 0
    v_mov_b32 v44, 0
    v_mov_b32 v45, 0
    v_mov_b32 v46, 0
    v_mov_b32 v47, 0
    s_mul_i32 s57, s56, 5120
    s_add_u32 s57, s57, 65536
    v_add_u32 v246, s57, v1
    s_xor_b32 s58, s56, 2
    s_mul_i32 s58, s58, 5120
    s_add_u32 s58, s58, 65536
    v_add_u32 v247, s58, v1
    s_lshl_b32 s68, s84, 6
    s_and_b32 s58, s56, 1
    s_lshl_b32 s58, s58, 5
    s_add_u32 s68, s68, s58
    s_lshr_b32 s58, s56, 1
    s_lshl_b32 s58, s58, 2
    s_add_u32 s68, s68, s58
    s_mul_i32 s68, s68, 1152
    s_mul_i32 s58, s85, 144
    s_add_u32 s68, s68, s58
    v_bfe_u32 v248, v0, 2, 2
    v_lshlrev_b32 v248, 3, v248
    v_and_b32 v249, 3, v0
    v_add_u32 v248, v248, v249
    v_mul_u32_u24 v248, 1152, v248
    v_lshrrev_b32 v249, 4, v0
    v_lshl_add_u32 v250, v249, 4, v248
    v_lshl_add_u32 v251, v249, 3, v248
    s_barrier
    ds_read_b64 v[48:49], v240 offset:0
    ds_read_b64 v[50:51], v240 offset:1024
    ds_read_b64 v[52:53], v240 offset:8
    ds_read_b64 v[54:55], v240 offset:1032
    ds_read_b64 v[56:57], v240 offset:2048
    ds_read_b64 v[58:59], v240 offset:3072
    ds_read_b64 v[60:61], v240 offset:2056
    ds_read_b64 v[62:63], v240 offset:3080
    s_waitcnt lgkmcnt(0)
    s_barrier
    v_mfma_f32_16x16x32_bf16 v[8:11], v[80:83], v[48:51], v[8:11]
    ds_read_b64 v[64:65], v240 offset:16384
    ds_read_b64 v[66:67], v240 offset:17408
    v_mfma_f32_16x16x32_bf16 v[28:31], v[80:83], v[52:55], v[28:31]
    ds_read_b64 v[68:69], v240 offset:16392
    v_mfma_f32_16x16x32_bf16 v[12:15], v[84:87], v[48:51], v[12:15]
    ds_read_b64 v[70:71], v240 offset:17416
    ds_read_b64 v[72:73], v240 offset:18432
    v_mfma_f32_16x16x32_bf16 v[32:35], v[84:87], v[52:55], v[32:35]
    ds_read_b64 v[74:75], v240 offset:19456
    v_mfma_f32_16x16x32_bf16 v[16:19], v[88:91], v[48:51], v[16:19]
    ds_read_b64 v[76:77], v240 offset:18440
    ds_read_b64 v[78:79], v240 offset:19464
    v_mfma_f32_16x16x32_bf16 v[36:39], v[88:91], v[52:55], v[36:39]
    v_mfma_f32_16x16x32_bf16 v[20:23], v[92:95], v[48:51], v[20:23]
    v_mfma_f32_16x16x32_bf16 v[40:43], v[92:95], v[52:55], v[40:43]
    v_mfma_f32_16x16x32_bf16 v[24:27], v[96:99], v[48:51], v[24:27]
    v_mfma_f32_16x16x32_bf16 v[44:47], v[96:99], v[52:55], v[44:47]
    v_mfma_f32_16x16x32_bf16 v[8:11], v[100:103], v[56:59], v[8:11]
    v_mfma_f32_16x16x32_bf16 v[28:31], v[100:103], v[60:63], v[28:31]
    v_mfma_f32_16x16x32_bf16 v[12:15], v[104:107], v[56:59], v[12:15]
    v_mfma_f32_16x16x32_bf16 v[32:35], v[104:107], v[60:63], v[32:35]
    v_mfma_f32_16x16x32_bf16 v[16:19], v[108:111], v[56:59], v[16:19]
    v_mfma_f32_16x16x32_bf16 v[36:39], v[108:111], v[60:63], v[36:39]
    v_mfma_f32_16x16x32_bf16 v[20:23], v[112:115], v[56:59], v[20:23]
    v_mfma_f32_16x16x32_bf16 v[40:43], v[112:115], v[60:63], v[40:43]
    v_mfma_f32_16x16x32_bf16 v[24:27], v[116:119], v[56:59], v[24:27]
    v_mfma_f32_16x16x32_bf16 v[44:47], v[116:119], v[60:63], v[44:47]
    s_waitcnt lgkmcnt(0)
    s_barrier
    v_mfma_f32_16x16x32_bf16 v[8:11], v[120:123], v[64:67], v[8:11]
    ds_read_b64 v[48:49], v240 offset:32768
    ds_read_b64 v[50:51], v240 offset:33792
    v_mfma_f32_16x16x32_bf16 v[28:31], v[120:123], v[68:71], v[28:31]
    ds_read_b64 v[52:53], v240 offset:32776
    v_mfma_f32_16x16x32_bf16 v[12:15], v[124:127], v[64:67], v[12:15]
    ds_read_b64 v[54:55], v240 offset:33800
    ds_read_b64 v[56:57], v240 offset:34816
    v_mfma_f32_16x16x32_bf16 v[32:35], v[124:127], v[68:71], v[32:35]
    ds_read_b64 v[58:59], v240 offset:35840
    v_mfma_f32_16x16x32_bf16 v[16:19], v[128:131], v[64:67], v[16:19]
    ds_read_b64 v[60:61], v240 offset:34824
    ds_read_b64 v[62:63], v240 offset:35848
    v_mfma_f32_16x16x32_bf16 v[36:39], v[128:131], v[68:71], v[36:39]
    ds_read_b128 v[80:83], v241 offset:0
    v_mfma_f32_16x16x32_bf16 v[20:23], v[132:135], v[64:67], v[20:23]
    ds_read_b128 v[84:87], v241 offset:1024
    ds_read_b128 v[88:91], v241 offset:2048
    v_mfma_f32_16x16x32_bf16 v[40:43], v[132:135], v[68:71], v[40:43]
    ds_read_b128 v[92:95], v241 offset:3072
    v_mfma_f32_16x16x32_bf16 v[24:27], v[136:139], v[64:67], v[24:27]
    ds_read_b128 v[96:99], v243 offset:4096
    ds_read_b128 v[100:103], v241 offset:4608
    v_mfma_f32_16x16x32_bf16 v[44:47], v[136:139], v[68:71], v[44:47]
    ds_read_b128 v[104:107], v241 offset:5632
    v_mfma_f32_16x16x32_bf16 v[8:11], v[140:143], v[72:75], v[8:11]
    ds_read_b128 v[108:111], v241 offset:6656
    ds_read_b128 v[112:115], v241 offset:7680
    v_mfma_f32_16x16x32_bf16 v[28:31], v[140:143], v[76:79], v[28:31]
    ds_read_b128 v[116:119], v243 offset:8704
    v_mfma_f32_16x16x32_bf16 v[12:15], v[144:147], v[72:75], v[12:15]
    v_mfma_f32_16x16x32_bf16 v[32:35], v[144:147], v[76:79], v[32:35]
    v_mfma_f32_16x16x32_bf16 v[16:19], v[148:151], v[72:75], v[16:19]
    v_mfma_f32_16x16x32_bf16 v[36:39], v[148:151], v[76:79], v[36:39]
    v_mfma_f32_16x16x32_bf16 v[20:23], v[152:155], v[72:75], v[20:23]
    v_mfma_f32_16x16x32_bf16 v[40:43], v[152:155], v[76:79], v[40:43]
    v_mfma_f32_16x16x32_bf16 v[24:27], v[156:159], v[72:75], v[24:27]
    v_mfma_f32_16x16x32_bf16 v[44:47], v[156:159], v[76:79], v[44:47]
    s_waitcnt lgkmcnt(0)
    s_barrier
    v_mfma_f32_16x16x32_bf16 v[8:11], v[160:163], v[48:51], v[8:11]
    ds_read_b64 v[64:65], v240 offset:49152
    ds_read_b64 v[66:67], v240 offset:50176
    v_mfma_f32_16x16x32_bf16 v[28:31], v[160:163], v[52:55], v[28:31]
    ds_read_b64 v[68:69], v240 offset:49160
    v_mfma_f32_16x16x32_bf16 v[12:15], v[164:167], v[48:51], v[12:15]
    ds_read_b64 v[70:71], v240 offset:50184
    ds_read_b64 v[72:73], v240 offset:51200
    v_mfma_f32_16x16x32_bf16 v[32:35], v[164:167], v[52:55], v[32:35]
    ds_read_b64 v[74:75], v240 offset:52224
    v_mfma_f32_16x16x32_bf16 v[16:19], v[168:171], v[48:51], v[16:19]
    ds_read_b64 v[76:77], v240 offset:51208
    ds_read_b64 v[78:79], v240 offset:52232
    v_mfma_f32_16x16x32_bf16 v[36:39], v[168:171], v[52:55], v[36:39]
    ds_read_b128 v[120:123], v241 offset:18432
    v_mfma_f32_16x16x32_bf16 v[20:23], v[172:175], v[48:51], v[20:23]
    ds_read_b128 v[124:127], v241 offset:19456
    ds_read_b128 v[128:131], v241 offset:20480
    v_mfma_f32_16x16x32_bf16 v[40:43], v[172:175], v[52:55], v[40:43]
    ds_read_b128 v[132:135], v241 offset:21504
    v_mfma_f32_16x16x32_bf16 v[24:27], v[176:179], v[48:51], v[24:27]
    ds_read_b128 v[136:139], v243 offset:22528
    ds_read_b128 v[140:143], v241 offset:23040
    v_mfma_f32_16x16x32_bf16 v[44:47], v[176:179], v[52:55], v[44:47]
    ds_read_b128 v[144:147], v241 offset:24064
    v_mfma_f32_16x16x32_bf16 v[8:11], v[180:183], v[56:59], v[8:11]
    ds_read_b128 v[148:151], v241 offset:25088
    ds_read_b128 v[152:155], v241 offset:26112
    v_mfma_f32_16x16x32_bf16 v[28:31], v[180:183], v[60:63], v[28:31]
    ds_read_b128 v[156:159], v243 offset:27136
    v_mfma_f32_16x16x32_bf16 v[12:15], v[184:187], v[56:59], v[12:15]
    v_mfma_f32_16x16x32_bf16 v[32:35], v[184:187], v[60:63], v[32:35]
    v_mfma_f32_16x16x32_bf16 v[16:19], v[188:191], v[56:59], v[16:19]
    v_mfma_f32_16x16x32_bf16 v[36:39], v[188:191], v[60:63], v[36:39]
    v_mfma_f32_16x16x32_bf16 v[20:23], v[192:195], v[56:59], v[20:23]
    v_mfma_f32_16x16x32_bf16 v[40:43], v[192:195], v[60:63], v[40:43]
    v_mfma_f32_16x16x32_bf16 v[24:27], v[196:199], v[56:59], v[24:27]
    v_mfma_f32_16x16x32_bf16 v[44:47], v[196:199], v[60:63], v[44:47]
    s_waitcnt lgkmcnt(0)
    s_barrier
    v_mfma_f32_16x16x32_bf16 v[8:11], v[200:203], v[64:67], v[8:11]
    ds_read_b64 v[48:49], v240 offset:0
    ds_read_b64 v[50:51], v240 offset:1024
    v_mfma_f32_16x16x32_bf16 v[28:31], v[200:203], v[68:71], v[28:31]
    ds_read_b64 v[52:53], v240 offset:8
    v_mfma_f32_16x16x32_bf16 v[12:15], v[204:207], v[64:67], v[12:15]
    ds_read_b64 v[54:55], v240 offset:1032
    ds_read_b64 v[56:57], v240 offset:2048
    v_mfma_f32_16x16x32_bf16 v[32:35], v[204:207], v[68:71], v[32:35]
    ds_read_b64 v[58:59], v240 offset:3072
    v_mfma_f32_16x16x32_bf16 v[16:19], v[208:211], v[64:67], v[16:19]
    ds_read_b64 v[60:61], v240 offset:2056
    ds_read_b64 v[62:63], v240 offset:3080
    v_mfma_f32_16x16x32_bf16 v[36:39], v[208:211], v[68:71], v[36:39]
    ds_read_b128 v[160:163], v241 offset:36864
    v_mfma_f32_16x16x32_bf16 v[20:23], v[212:215], v[64:67], v[20:23]
    ds_read_b128 v[164:167], v241 offset:37888
    ds_read_b128 v[168:171], v241 offset:38912
    v_mfma_f32_16x16x32_bf16 v[40:43], v[212:215], v[68:71], v[40:43]
    ds_read_b128 v[172:175], v241 offset:39936
    v_mfma_f32_16x16x32_bf16 v[24:27], v[216:219], v[64:67], v[24:27]
    ds_read_b128 v[176:179], v243 offset:40960
    ds_read_b128 v[180:183], v241 offset:41472
    v_mfma_f32_16x16x32_bf16 v[44:47], v[216:219], v[68:71], v[44:47]
    ds_read_b128 v[184:187], v241 offset:42496
    v_mfma_f32_16x16x32_bf16 v[8:11], v[220:223], v[72:75], v[8:11]
    ds_read_b128 v[188:191], v241 offset:43520
    ds_read_b128 v[192:195], v241 offset:44544
    v_mfma_f32_16x16x32_bf16 v[28:31], v[220:223], v[76:79], v[28:31]
    ds_read_b128 v[196:199], v243 offset:45568
    v_mfma_f32_16x16x32_bf16 v[12:15], v[224:227], v[72:75], v[12:15]
    v_mfma_f32_16x16x32_bf16 v[32:35], v[224:227], v[76:79], v[32:35]
    v_mfma_f32_16x16x32_bf16 v[16:19], v[228:231], v[72:75], v[16:19]
    v_mfma_f32_16x16x32_bf16 v[36:39], v[228:231], v[76:79], v[36:39]
    v_mfma_f32_16x16x32_bf16 v[20:23], v[232:235], v[72:75], v[20:23]
    v_mfma_f32_16x16x32_bf16 v[40:43], v[232:235], v[76:79], v[40:43]
    v_mfma_f32_16x16x32_bf16 v[24:27], v[236:239], v[72:75], v[24:27]
    v_mfma_f32_16x16x32_bf16 v[44:47], v[236:239], v[76:79], v[44:47]
    s_waitcnt lgkmcnt(0)
    s_barrier
    v_mfma_f32_16x16x32_bf16 v[8:11], v[80:83], v[48:51], v[8:11]
    ds_read_b64 v[64:65], v240 offset:16384
    ds_read_b64 v[66:67], v240 offset:17408
    v_mfma_f32_16x16x32_bf16 v[28:31], v[80:83], v[52:55], v[28:31]
    ds_read_b64 v[68:69], v240 offset:16392
    v_mfma_f32_16x16x32_bf16 v[12:15], v[84:87], v[48:51], v[12:15]
    ds_read_b64 v[70:71], v240 offset:17416
    ds_read_b64 v[72:73], v240 offset:18432
    v_mfma_f32_16x16x32_bf16 v[32:35], v[84:87], v[52:55], v[32:35]
    ds_read_b64 v[74:75], v240 offset:19456
    v_mfma_f32_16x16x32_bf16 v[16:19], v[88:91], v[48:51], v[16:19]
    ds_read_b64 v[76:77], v240 offset:18440
    ds_read_b64 v[78:79], v240 offset:19464
    v_mfma_f32_16x16x32_bf16 v[36:39], v[88:91], v[52:55], v[36:39]
    ds_read_b128 v[200:203], v242 offset:0
    v_mfma_f32_16x16x32_bf16 v[20:23], v[92:95], v[48:51], v[20:23]
    ds_read_b128 v[204:207], v242 offset:1024
    ds_read_b128 v[208:211], v242 offset:2048
    v_mfma_f32_16x16x32_bf16 v[40:43], v[92:95], v[52:55], v[40:43]
    ds_read_b128 v[212:215], v242 offset:3072
    v_mfma_f32_16x16x32_bf16 v[24:27], v[96:99], v[48:51], v[24:27]
    ds_read_b128 v[216:219], v244 offset:4096
    ds_read_b128 v[220:223], v242 offset:4608
    v_mfma_f32_16x16x32_bf16 v[44:47], v[96:99], v[52:55], v[44:47]
    ds_read_b128 v[224:227], v242 offset:5632
    v_mfma_f32_16x16x32_bf16 v[8:11], v[100:103], v[56:59], v[8:11]
    ds_read_b128 v[228:231], v242 offset:6656
    ds_read_b128 v[232:235], v242 offset:7680
    v_mfma_f32_16x16x32_bf16 v[28:31], v[100:103], v[60:63], v[28:31]
    ds_read_b128 v[236:239], v244 offset:8704
    v_mfma_f32_16x16x32_bf16 v[12:15], v[104:107], v[56:59], v[12:15]
    v_mfma_f32_16x16x32_bf16 v[32:35], v[104:107], v[60:63], v[32:35]
    v_mfma_f32_16x16x32_bf16 v[16:19], v[108:111], v[56:59], v[16:19]
    v_mfma_f32_16x16x32_bf16 v[36:39], v[108:111], v[60:63], v[36:39]
    v_mfma_f32_16x16x32_bf16 v[20:23], v[112:115], v[56:59], v[20:23]
    v_mfma_f32_16x16x32_bf16 v[40:43], v[112:115], v[60:63], v[40:43]
    v_mfma_f32_16x16x32_bf16 v[24:27], v[116:119], v[56:59], v[24:27]
    v_mfma_f32_16x16x32_bf16 v[44:47], v[116:119], v[60:63], v[44:47]
    s_waitcnt lgkmcnt(0)
    s_barrier
    v_mfma_f32_16x16x32_bf16 v[8:11], v[120:123], v[64:67], v[8:11]
    ds_read_b64 v[48:49], v240 offset:32768
    ds_read_b64 v[50:51], v240 offset:33792
    v_mfma_f32_16x16x32_bf16 v[28:31], v[120:123], v[68:71], v[28:31]
    ds_read_b64 v[52:53], v240 offset:32776
    v_mfma_f32_16x16x32_bf16 v[12:15], v[124:127], v[64:67], v[12:15]
    ds_read_b64 v[54:55], v240 offset:33800
    ds_read_b64 v[56:57], v240 offset:34816
    v_mfma_f32_16x16x32_bf16 v[32:35], v[124:127], v[68:71], v[32:35]
    ds_read_b64 v[58:59], v240 offset:35840
    v_mfma_f32_16x16x32_bf16 v[16:19], v[128:131], v[64:67], v[16:19]
    ds_read_b64 v[60:61], v240 offset:34824
    ds_read_b64 v[62:63], v240 offset:35848
    v_mfma_f32_16x16x32_bf16 v[36:39], v[128:131], v[68:71], v[36:39]
    ds_read_b128 v[80:83], v242 offset:18432
    v_mfma_f32_16x16x32_bf16 v[20:23], v[132:135], v[64:67], v[20:23]
    ds_read_b128 v[84:87], v242 offset:19456
    ds_read_b128 v[88:91], v242 offset:20480
    v_mfma_f32_16x16x32_bf16 v[40:43], v[132:135], v[68:71], v[40:43]
    ds_read_b128 v[92:95], v242 offset:21504
    v_mfma_f32_16x16x32_bf16 v[24:27], v[136:139], v[64:67], v[24:27]
    ds_read_b128 v[96:99], v244 offset:22528
    ds_read_b128 v[100:103], v242 offset:23040
    v_mfma_f32_16x16x32_bf16 v[44:47], v[136:139], v[68:71], v[44:47]
    ds_read_b128 v[104:107], v242 offset:24064
    v_mfma_f32_16x16x32_bf16 v[8:11], v[140:143], v[72:75], v[8:11]
    ds_read_b128 v[108:111], v242 offset:25088
    ds_read_b128 v[112:115], v242 offset:26112
    v_mfma_f32_16x16x32_bf16 v[28:31], v[140:143], v[76:79], v[28:31]
    ds_read_b128 v[116:119], v244 offset:27136
    v_mfma_f32_16x16x32_bf16 v[12:15], v[144:147], v[72:75], v[12:15]
    v_mfma_f32_16x16x32_bf16 v[32:35], v[144:147], v[76:79], v[32:35]
    v_mfma_f32_16x16x32_bf16 v[16:19], v[148:151], v[72:75], v[16:19]
    v_mfma_f32_16x16x32_bf16 v[36:39], v[148:151], v[76:79], v[36:39]
    v_mfma_f32_16x16x32_bf16 v[20:23], v[152:155], v[72:75], v[20:23]
    v_mfma_f32_16x16x32_bf16 v[40:43], v[152:155], v[76:79], v[40:43]
    v_mfma_f32_16x16x32_bf16 v[24:27], v[156:159], v[72:75], v[24:27]
    v_mfma_f32_16x16x32_bf16 v[44:47], v[156:159], v[76:79], v[44:47]
    s_waitcnt lgkmcnt(0)
    s_barrier
    v_mfma_f32_16x16x32_bf16 v[8:11], v[160:163], v[48:51], v[8:11]
    ds_read_b64 v[64:65], v240 offset:49152
    ds_read_b64 v[66:67], v240 offset:50176
    v_mfma_f32_16x16x32_bf16 v[28:31], v[160:163], v[52:55], v[28:31]
    ds_read_b64 v[68:69], v240 offset:49160
    v_mfma_f32_16x16x32_bf16 v[12:15], v[164:167], v[48:51], v[12:15]
    ds_read_b64 v[70:71], v240 offset:50184
    ds_read_b64 v[72:73], v240 offset:51200
    v_mfma_f32_16x16x32_bf16 v[32:35], v[164:167], v[52:55], v[32:35]
    ds_read_b64 v[74:75], v240 offset:52224
    v_mfma_f32_16x16x32_bf16 v[16:19], v[168:171], v[48:51], v[16:19]
    ds_read_b64 v[76:77], v240 offset:51208
    ds_read_b64 v[78:79], v240 offset:52232
    v_mfma_f32_16x16x32_bf16 v[36:39], v[168:171], v[52:55], v[36:39]
    ds_read_b128 v[120:123], v241 offset:0
    v_mfma_f32_16x16x32_bf16 v[20:23], v[172:175], v[48:51], v[20:23]
    ds_read_b128 v[124:127], v241 offset:1024
    ds_read_b128 v[128:131], v241 offset:2048
    v_mfma_f32_16x16x32_bf16 v[40:43], v[172:175], v[52:55], v[40:43]
    ds_read_b128 v[132:135], v241 offset:3072
    v_mfma_f32_16x16x32_bf16 v[24:27], v[176:179], v[48:51], v[24:27]
    ds_read_b128 v[136:139], v243 offset:4096
    ds_read_b128 v[140:143], v241 offset:4608
    v_mfma_f32_16x16x32_bf16 v[44:47], v[176:179], v[52:55], v[44:47]
    ds_read_b128 v[144:147], v241 offset:5632
    v_mfma_f32_16x16x32_bf16 v[8:11], v[180:183], v[56:59], v[8:11]
    ds_read_b128 v[148:151], v241 offset:6656
    ds_read_b128 v[152:155], v241 offset:7680
    v_mfma_f32_16x16x32_bf16 v[28:31], v[180:183], v[60:63], v[28:31]
    ds_read_b128 v[156:159], v243 offset:8704
    v_mfma_f32_16x16x32_bf16 v[12:15], v[184:187], v[56:59], v[12:15]
    v_mfma_f32_16x16x32_bf16 v[32:35], v[184:187], v[60:63], v[32:35]
    v_mfma_f32_16x16x32_bf16 v[16:19], v[188:191], v[56:59], v[16:19]
    v_mfma_f32_16x16x32_bf16 v[36:39], v[188:191], v[60:63], v[36:39]
    v_mfma_f32_16x16x32_bf16 v[20:23], v[192:195], v[56:59], v[20:23]
    v_mfma_f32_16x16x32_bf16 v[40:43], v[192:195], v[60:63], v[40:43]
    v_mfma_f32_16x16x32_bf16 v[24:27], v[196:199], v[56:59], v[24:27]
    v_mfma_f32_16x16x32_bf16 v[44:47], v[196:199], v[60:63], v[44:47]
    s_waitcnt lgkmcnt(0)
    s_barrier
    v_mfma_f32_16x16x32_bf16 v[8:11], v[200:203], v[64:67], v[8:11]
    ds_read_b64 v[48:49], v240 offset:0
    ds_read_b64 v[50:51], v240 offset:1024
    v_mfma_f32_16x16x32_bf16 v[28:31], v[200:203], v[68:71], v[28:31]
    ds_read_b64 v[52:53], v240 offset:8
    v_mfma_f32_16x16x32_bf16 v[12:15], v[204:207], v[64:67], v[12:15]
    ds_read_b64 v[54:55], v240 offset:1032
    ds_read_b64 v[56:57], v240 offset:2048
    v_mfma_f32_16x16x32_bf16 v[32:35], v[204:207], v[68:71], v[32:35]
    ds_read_b64 v[58:59], v240 offset:3072
    v_mfma_f32_16x16x32_bf16 v[16:19], v[208:211], v[64:67], v[16:19]
    ds_read_b64 v[60:61], v240 offset:2056
    ds_read_b64 v[62:63], v240 offset:3080
    v_mfma_f32_16x16x32_bf16 v[36:39], v[208:211], v[68:71], v[36:39]
    ds_read_b128 v[160:163], v241 offset:18432
    v_mfma_f32_16x16x32_bf16 v[20:23], v[212:215], v[64:67], v[20:23]
    ds_read_b128 v[164:167], v241 offset:19456
    ds_read_b128 v[168:171], v241 offset:20480
    v_mfma_f32_16x16x32_bf16 v[40:43], v[212:215], v[68:71], v[40:43]
    ds_read_b128 v[172:175], v241 offset:21504
    v_mfma_f32_16x16x32_bf16 v[24:27], v[216:219], v[64:67], v[24:27]
    ds_read_b128 v[176:179], v243 offset:22528
    ds_read_b128 v[180:183], v241 offset:23040
    v_mfma_f32_16x16x32_bf16 v[44:47], v[216:219], v[68:71], v[44:47]
    ds_read_b128 v[184:187], v241 offset:24064
    v_mfma_f32_16x16x32_bf16 v[8:11], v[220:223], v[72:75], v[8:11]
    ds_read_b128 v[188:191], v241 offset:25088
    ds_read_b128 v[192:195], v241 offset:26112
    v_mfma_f32_16x16x32_bf16 v[28:31], v[220:223], v[76:79], v[28:31]
    ds_read_b128 v[196:199], v243 offset:27136
    v_mfma_f32_16x16x32_bf16 v[12:15], v[224:227], v[72:75], v[12:15]
    v_mfma_f32_16x16x32_bf16 v[32:35], v[224:227], v[76:79], v[32:35]
    v_mfma_f32_16x16x32_bf16 v[16:19], v[228:231], v[72:75], v[16:19]
    v_mfma_f32_16x16x32_bf16 v[36:39], v[228:231], v[76:79], v[36:39]
    v_mfma_f32_16x16x32_bf16 v[20:23], v[232:235], v[72:75], v[20:23]
    v_mfma_f32_16x16x32_bf16 v[40:43], v[232:235], v[76:79], v[40:43]
    v_mfma_f32_16x16x32_bf16 v[24:27], v[236:239], v[72:75], v[24:27]
    v_mfma_f32_16x16x32_bf16 v[44:47], v[236:239], v[76:79], v[44:47]
    s_waitcnt lgkmcnt(0)
    s_barrier
    v_mfma_f32_16x16x32_bf16 v[8:11], v[80:83], v[48:51], v[8:11]
    ds_read_b64 v[64:65], v240 offset:16384
    ds_read_b64 v[66:67], v240 offset:17408
    v_mfma_f32_16x16x32_bf16 v[28:31], v[80:83], v[52:55], v[28:31]
    ds_read_b64 v[68:69], v240 offset:16392
    v_mfma_f32_16x16x32_bf16 v[12:15], v[84:87], v[48:51], v[12:15]
    ds_read_b64 v[70:71], v240 offset:17416
    ds_read_b64 v[72:73], v240 offset:18432
    v_mfma_f32_16x16x32_bf16 v[32:35], v[84:87], v[52:55], v[32:35]
    ds_read_b64 v[74:75], v240 offset:19456
    v_mfma_f32_16x16x32_bf16 v[16:19], v[88:91], v[48:51], v[16:19]
    ds_read_b64 v[76:77], v240 offset:18440
    ds_read_b64 v[78:79], v240 offset:19464
    v_mfma_f32_16x16x32_bf16 v[36:39], v[88:91], v[52:55], v[36:39]
    v_mfma_f32_16x16x32_bf16 v[20:23], v[92:95], v[48:51], v[20:23]
    v_mfma_f32_16x16x32_bf16 v[40:43], v[92:95], v[52:55], v[40:43]
    v_mfma_f32_16x16x32_bf16 v[24:27], v[96:99], v[48:51], v[24:27]
    v_mfma_f32_16x16x32_bf16 v[44:47], v[96:99], v[52:55], v[44:47]
    v_mfma_f32_16x16x32_bf16 v[8:11], v[100:103], v[56:59], v[8:11]
    v_mfma_f32_16x16x32_bf16 v[28:31], v[100:103], v[60:63], v[28:31]
    v_mfma_f32_16x16x32_bf16 v[12:15], v[104:107], v[56:59], v[12:15]
    v_mfma_f32_16x16x32_bf16 v[32:35], v[104:107], v[60:63], v[32:35]
    v_mfma_f32_16x16x32_bf16 v[16:19], v[108:111], v[56:59], v[16:19]
    v_mfma_f32_16x16x32_bf16 v[36:39], v[108:111], v[60:63], v[36:39]
    v_mfma_f32_16x16x32_bf16 v[20:23], v[112:115], v[56:59], v[20:23]
    v_mfma_f32_16x16x32_bf16 v[40:43], v[112:115], v[60:63], v[40:43]
    v_mfma_f32_16x16x32_bf16 v[24:27], v[116:119], v[56:59], v[24:27]
    v_mfma_f32_16x16x32_bf16 v[44:47], v[116:119], v[60:63], v[44:47]
    s_waitcnt lgkmcnt(0)
    s_barrier
    v_mfma_f32_16x16x32_bf16 v[8:11], v[120:123], v[64:67], v[8:11]
    ds_read_b64 v[48:49], v240 offset:32768
    ds_read_b64 v[50:51], v240 offset:33792
    v_mfma_f32_16x16x32_bf16 v[28:31], v[120:123], v[68:71], v[28:31]
    ds_read_b64 v[52:53], v240 offset:32776
    v_mfma_f32_16x16x32_bf16 v[12:15], v[124:127], v[64:67], v[12:15]
    ds_read_b64 v[54:55], v240 offset:33800
    ds_read_b64 v[56:57], v240 offset:34816
    v_mfma_f32_16x16x32_bf16 v[32:35], v[124:127], v[68:71], v[32:35]
    ds_read_b64 v[58:59], v240 offset:35840
    v_mfma_f32_16x16x32_bf16 v[16:19], v[128:131], v[64:67], v[16:19]
    ds_read_b64 v[60:61], v240 offset:34824
    ds_read_b64 v[62:63], v240 offset:35848
    v_mfma_f32_16x16x32_bf16 v[36:39], v[128:131], v[68:71], v[36:39]
    ds_read_b128 v[200:203], v241 offset:36864
    v_mfma_f32_16x16x32_bf16 v[20:23], v[132:135], v[64:67], v[20:23]
    ds_read_b128 v[204:207], v241 offset:37888
    ds_read_b128 v[208:211], v241 offset:38912
    v_mfma_f32_16x16x32_bf16 v[40:43], v[132:135], v[68:71], v[40:43]
    ds_read_b128 v[212:215], v241 offset:39936
    v_mfma_f32_16x16x32_bf16 v[24:27], v[136:139], v[64:67], v[24:27]
    ds_read_b128 v[216:219], v243 offset:40960
    ds_read_b128 v[220:223], v241 offset:41472
    v_mfma_f32_16x16x32_bf16 v[44:47], v[136:139], v[68:71], v[44:47]
    ds_read_b128 v[224:227], v241 offset:42496
    v_mfma_f32_16x16x32_bf16 v[8:11], v[140:143], v[72:75], v[8:11]
    ds_read_b128 v[228:231], v241 offset:43520
    ds_read_b128 v[232:235], v241 offset:44544
    v_mfma_f32_16x16x32_bf16 v[28:31], v[140:143], v[76:79], v[28:31]
    ds_read_b128 v[236:239], v243 offset:45568
    v_mfma_f32_16x16x32_bf16 v[12:15], v[144:147], v[72:75], v[12:15]
    v_mfma_f32_16x16x32_bf16 v[32:35], v[144:147], v[76:79], v[32:35]
    v_mfma_f32_16x16x32_bf16 v[16:19], v[148:151], v[72:75], v[16:19]
    v_mfma_f32_16x16x32_bf16 v[36:39], v[148:151], v[76:79], v[36:39]
    v_mfma_f32_16x16x32_bf16 v[20:23], v[152:155], v[72:75], v[20:23]
    v_mfma_f32_16x16x32_bf16 v[40:43], v[152:155], v[76:79], v[40:43]
    v_mfma_f32_16x16x32_bf16 v[24:27], v[156:159], v[72:75], v[24:27]
    v_mfma_f32_16x16x32_bf16 v[44:47], v[156:159], v[76:79], v[44:47]
    s_waitcnt lgkmcnt(0)
    s_barrier
    v_mfma_f32_16x16x32_bf16 v[8:11], v[160:163], v[48:51], v[8:11]
    ds_read_b64 v[64:65], v240 offset:49152
    ds_read_b64 v[66:67], v240 offset:50176
    v_mfma_f32_16x16x32_bf16 v[28:31], v[160:163], v[52:55], v[28:31]
    ds_read_b64 v[68:69], v240 offset:49160
    v_mfma_f32_16x16x32_bf16 v[12:15], v[164:167], v[48:51], v[12:15]
    ds_read_b64 v[70:71], v240 offset:50184
    ds_read_b64 v[72:73], v240 offset:51200
    v_mfma_f32_16x16x32_bf16 v[32:35], v[164:167], v[52:55], v[32:35]
    ds_read_b64 v[74:75], v240 offset:52224
    v_mfma_f32_16x16x32_bf16 v[16:19], v[168:171], v[48:51], v[16:19]
    ds_read_b64 v[76:77], v240 offset:51208
    ds_read_b64 v[78:79], v240 offset:52232
    v_mfma_f32_16x16x32_bf16 v[36:39], v[168:171], v[52:55], v[36:39]
    ds_read_b128 v[80:83], v242 offset:0
    v_mfma_f32_16x16x32_bf16 v[20:23], v[172:175], v[48:51], v[20:23]
    ds_read_b128 v[84:87], v242 offset:1024
    ds_read_b128 v[88:91], v242 offset:2048
    v_mfma_f32_16x16x32_bf16 v[40:43], v[172:175], v[52:55], v[40:43]
    ds_read_b128 v[92:95], v242 offset:3072
    v_mfma_f32_16x16x32_bf16 v[24:27], v[176:179], v[48:51], v[24:27]
    ds_read_b128 v[96:99], v244 offset:4096
    ds_read_b128 v[100:103], v242 offset:4608
    v_mfma_f32_16x16x32_bf16 v[44:47], v[176:179], v[52:55], v[44:47]
    ds_read_b128 v[104:107], v242 offset:5632
    v_mfma_f32_16x16x32_bf16 v[8:11], v[180:183], v[56:59], v[8:11]
    ds_read_b128 v[108:111], v242 offset:6656
    ds_read_b128 v[112:115], v242 offset:7680
    v_mfma_f32_16x16x32_bf16 v[28:31], v[180:183], v[60:63], v[28:31]
    ds_read_b128 v[116:119], v244 offset:8704
    v_mfma_f32_16x16x32_bf16 v[12:15], v[184:187], v[56:59], v[12:15]
    v_mfma_f32_16x16x32_bf16 v[32:35], v[184:187], v[60:63], v[32:35]
    v_mfma_f32_16x16x32_bf16 v[16:19], v[188:191], v[56:59], v[16:19]
    v_mfma_f32_16x16x32_bf16 v[36:39], v[188:191], v[60:63], v[36:39]
    v_mfma_f32_16x16x32_bf16 v[20:23], v[192:195], v[56:59], v[20:23]
    v_mfma_f32_16x16x32_bf16 v[40:43], v[192:195], v[60:63], v[40:43]
    v_mfma_f32_16x16x32_bf16 v[24:27], v[196:199], v[56:59], v[24:27]
    v_mfma_f32_16x16x32_bf16 v[44:47], v[196:199], v[60:63], v[44:47]
    s_waitcnt lgkmcnt(0)
    s_barrier
    v_mfma_f32_16x16x32_bf16 v[8:11], v[200:203], v[64:67], v[8:11]
    ds_read_b64 v[48:49], v240 offset:0
    ds_read_b64 v[50:51], v240 offset:1024
    v_mfma_f32_16x16x32_bf16 v[28:31], v[200:203], v[68:71], v[28:31]
    ds_read_b64 v[52:53], v240 offset:8
    v_mfma_f32_16x16x32_bf16 v[12:15], v[204:207], v[64:67], v[12:15]
    ds_read_b64 v[54:55], v240 offset:1032
    ds_read_b64 v[56:57], v240 offset:2048
    v_mfma_f32_16x16x32_bf16 v[32:35], v[204:207], v[68:71], v[32:35]
    ds_read_b64 v[58:59], v240 offset:3072
    v_mfma_f32_16x16x32_bf16 v[16:19], v[208:211], v[64:67], v[16:19]
    ds_read_b64 v[60:61], v240 offset:2056
    ds_read_b64 v[62:63], v240 offset:3080
    v_mfma_f32_16x16x32_bf16 v[36:39], v[208:211], v[68:71], v[36:39]
    v_mfma_f32_16x16x32_bf16 v[20:23], v[212:215], v[64:67], v[20:23]
    v_mfma_f32_16x16x32_bf16 v[40:43], v[212:215], v[68:71], v[40:43]
    v_mfma_f32_16x16x32_bf16 v[24:27], v[216:219], v[64:67], v[24:27]
    v_mfma_f32_16x16x32_bf16 v[44:47], v[216:219], v[68:71], v[44:47]
    v_mfma_f32_16x16x32_bf16 v[8:11], v[220:223], v[72:75], v[8:11]
    v_mfma_f32_16x16x32_bf16 v[28:31], v[220:223], v[76:79], v[28:31]
    v_mfma_f32_16x16x32_bf16 v[12:15], v[224:227], v[72:75], v[12:15]
    v_mfma_f32_16x16x32_bf16 v[32:35], v[224:227], v[76:79], v[32:35]
    v_mfma_f32_16x16x32_bf16 v[16:19], v[228:231], v[72:75], v[16:19]
    v_mfma_f32_16x16x32_bf16 v[36:39], v[228:231], v[76:79], v[36:39]
    v_mfma_f32_16x16x32_bf16 v[20:23], v[232:235], v[72:75], v[20:23]
    v_mfma_f32_16x16x32_bf16 v[40:43], v[232:235], v[76:79], v[40:43]
    v_mfma_f32_16x16x32_bf16 v[24:27], v[236:239], v[72:75], v[24:27]
    v_mfma_f32_16x16x32_bf16 v[44:47], v[236:239], v[76:79], v[44:47]
    s_waitcnt lgkmcnt(0)
    s_barrier
    v_mfma_f32_16x16x32_bf16 v[8:11], v[80:83], v[48:51], v[8:11]
    ds_read_b64 v[64:65], v240 offset:16384
    ds_read_b64 v[66:67], v240 offset:17408
    v_mfma_f32_16x16x32_bf16 v[28:31], v[80:83], v[52:55], v[28:31]
    ds_read_b64 v[68:69], v240 offset:16392
    v_mfma_f32_16x16x32_bf16 v[12:15], v[84:87], v[48:51], v[12:15]
    ds_read_b64 v[70:71], v240 offset:17416
    ds_read_b64 v[72:73], v240 offset:18432
    v_mfma_f32_16x16x32_bf16 v[32:35], v[84:87], v[52:55], v[32:35]
    ds_read_b64 v[74:75], v240 offset:19456
    v_mfma_f32_16x16x32_bf16 v[16:19], v[88:91], v[48:51], v[16:19]
    ds_read_b64 v[76:77], v240 offset:18440
    ds_read_b64 v[78:79], v240 offset:19464
    v_mfma_f32_16x16x32_bf16 v[36:39], v[88:91], v[52:55], v[36:39]
    ds_read_b128 v[120:123], v242 offset:18432
    v_mfma_f32_16x16x32_bf16 v[20:23], v[92:95], v[48:51], v[20:23]
    ds_read_b128 v[124:127], v242 offset:19456
    ds_read_b128 v[128:131], v242 offset:20480
    v_mfma_f32_16x16x32_bf16 v[40:43], v[92:95], v[52:55], v[40:43]
    ds_read_b128 v[132:135], v242 offset:21504
    v_mfma_f32_16x16x32_bf16 v[24:27], v[96:99], v[48:51], v[24:27]
    ds_read_b128 v[136:139], v244 offset:22528
    ds_read_b128 v[140:143], v242 offset:23040
    v_mfma_f32_16x16x32_bf16 v[44:47], v[96:99], v[52:55], v[44:47]
    ds_read_b128 v[144:147], v242 offset:24064
    v_mfma_f32_16x16x32_bf16 v[8:11], v[100:103], v[56:59], v[8:11]
    ds_read_b128 v[148:151], v242 offset:25088
    ds_read_b128 v[152:155], v242 offset:26112
    v_mfma_f32_16x16x32_bf16 v[28:31], v[100:103], v[60:63], v[28:31]
    ds_read_b128 v[156:159], v244 offset:27136
    v_mfma_f32_16x16x32_bf16 v[12:15], v[104:107], v[56:59], v[12:15]
    v_mfma_f32_16x16x32_bf16 v[32:35], v[104:107], v[60:63], v[32:35]
    v_mfma_f32_16x16x32_bf16 v[16:19], v[108:111], v[56:59], v[16:19]
    v_mfma_f32_16x16x32_bf16 v[36:39], v[108:111], v[60:63], v[36:39]
    v_mfma_f32_16x16x32_bf16 v[20:23], v[112:115], v[56:59], v[20:23]
    v_mfma_f32_16x16x32_bf16 v[40:43], v[112:115], v[60:63], v[40:43]
    v_mfma_f32_16x16x32_bf16 v[24:27], v[116:119], v[56:59], v[24:27]
    v_mfma_f32_16x16x32_bf16 v[44:47], v[116:119], v[60:63], v[44:47]
    s_waitcnt lgkmcnt(0)
    s_barrier
    v_mfma_f32_16x16x32_bf16 v[8:11], v[120:123], v[64:67], v[8:11]
    ds_read_b64 v[48:49], v240 offset:32768
    ds_read_b64 v[50:51], v240 offset:33792
    v_mfma_f32_16x16x32_bf16 v[28:31], v[120:123], v[68:71], v[28:31]
    ds_read_b64 v[52:53], v240 offset:32776
    v_mfma_f32_16x16x32_bf16 v[12:15], v[124:127], v[64:67], v[12:15]
    ds_read_b64 v[54:55], v240 offset:33800
    ds_read_b64 v[56:57], v240 offset:34816
    v_mfma_f32_16x16x32_bf16 v[32:35], v[124:127], v[68:71], v[32:35]
    ds_read_b64 v[58:59], v240 offset:35840
    v_mfma_f32_16x16x32_bf16 v[16:19], v[128:131], v[64:67], v[16:19]
    ds_read_b64 v[60:61], v240 offset:34824
    ds_read_b64 v[62:63], v240 offset:35848
    v_mfma_f32_16x16x32_bf16 v[36:39], v[128:131], v[68:71], v[36:39]
    ds_read_b128 v[160:163], v241 offset:0
    v_mfma_f32_16x16x32_bf16 v[20:23], v[132:135], v[64:67], v[20:23]
    ds_read_b128 v[164:167], v241 offset:1024
    ds_read_b128 v[168:171], v241 offset:2048
    v_mfma_f32_16x16x32_bf16 v[40:43], v[132:135], v[68:71], v[40:43]
    ds_read_b128 v[172:175], v241 offset:3072
    v_mfma_f32_16x16x32_bf16 v[24:27], v[136:139], v[64:67], v[24:27]
    ds_read_b128 v[176:179], v243 offset:4096
    ds_read_b128 v[180:183], v241 offset:4608
    v_mfma_f32_16x16x32_bf16 v[44:47], v[136:139], v[68:71], v[44:47]
    ds_read_b128 v[184:187], v241 offset:5632
    v_mfma_f32_16x16x32_bf16 v[8:11], v[140:143], v[72:75], v[8:11]
    ds_read_b128 v[188:191], v241 offset:6656
    ds_read_b128 v[192:195], v241 offset:7680
    v_mfma_f32_16x16x32_bf16 v[28:31], v[140:143], v[76:79], v[28:31]
    ds_read_b128 v[196:199], v243 offset:8704
    v_mfma_f32_16x16x32_bf16 v[12:15], v[144:147], v[72:75], v[12:15]
    v_mfma_f32_16x16x32_bf16 v[32:35], v[144:147], v[76:79], v[32:35]
    v_mfma_f32_16x16x32_bf16 v[16:19], v[148:151], v[72:75], v[16:19]
    v_mfma_f32_16x16x32_bf16 v[36:39], v[148:151], v[76:79], v[36:39]
    v_mfma_f32_16x16x32_bf16 v[20:23], v[152:155], v[72:75], v[20:23]
    v_mfma_f32_16x16x32_bf16 v[40:43], v[152:155], v[76:79], v[40:43]
    v_mfma_f32_16x16x32_bf16 v[24:27], v[156:159], v[72:75], v[24:27]
    v_mfma_f32_16x16x32_bf16 v[44:47], v[156:159], v[76:79], v[44:47]
    s_waitcnt lgkmcnt(0)
    s_barrier
    v_mfma_f32_16x16x32_bf16 v[8:11], v[160:163], v[48:51], v[8:11]
    ds_read_b64 v[64:65], v240 offset:49152
    ds_read_b64 v[66:67], v240 offset:50176
    v_mfma_f32_16x16x32_bf16 v[28:31], v[160:163], v[52:55], v[28:31]
    ds_read_b64 v[68:69], v240 offset:49160
    v_mfma_f32_16x16x32_bf16 v[12:15], v[164:167], v[48:51], v[12:15]
    ds_read_b64 v[70:71], v240 offset:50184
    ds_read_b64 v[72:73], v240 offset:51200
    v_mfma_f32_16x16x32_bf16 v[32:35], v[164:167], v[52:55], v[32:35]
    ds_read_b64 v[74:75], v240 offset:52224
    v_mfma_f32_16x16x32_bf16 v[16:19], v[168:171], v[48:51], v[16:19]
    ds_read_b64 v[76:77], v240 offset:51208
    ds_read_b64 v[78:79], v240 offset:52232
    v_mfma_f32_16x16x32_bf16 v[36:39], v[168:171], v[52:55], v[36:39]
    ds_read_b128 v[200:203], v241 offset:18432
    v_mfma_f32_16x16x32_bf16 v[20:23], v[172:175], v[48:51], v[20:23]
    ds_read_b128 v[204:207], v241 offset:19456
    ds_read_b128 v[208:211], v241 offset:20480
    v_mfma_f32_16x16x32_bf16 v[40:43], v[172:175], v[52:55], v[40:43]
    ds_read_b128 v[212:215], v241 offset:21504
    v_mfma_f32_16x16x32_bf16 v[24:27], v[176:179], v[48:51], v[24:27]
    ds_read_b128 v[216:219], v243 offset:22528
    ds_read_b128 v[220:223], v241 offset:23040
    v_mfma_f32_16x16x32_bf16 v[44:47], v[176:179], v[52:55], v[44:47]
    ds_read_b128 v[224:227], v241 offset:24064
    v_mfma_f32_16x16x32_bf16 v[8:11], v[180:183], v[56:59], v[8:11]
    ds_read_b128 v[228:231], v241 offset:25088
    ds_read_b128 v[232:235], v241 offset:26112
    v_mfma_f32_16x16x32_bf16 v[28:31], v[180:183], v[60:63], v[28:31]
    ds_read_b128 v[236:239], v243 offset:27136
    v_mfma_f32_16x16x32_bf16 v[12:15], v[184:187], v[56:59], v[12:15]
    v_mfma_f32_16x16x32_bf16 v[32:35], v[184:187], v[60:63], v[32:35]
    v_mfma_f32_16x16x32_bf16 v[16:19], v[188:191], v[56:59], v[16:19]
    v_mfma_f32_16x16x32_bf16 v[36:39], v[188:191], v[60:63], v[36:39]
    v_mfma_f32_16x16x32_bf16 v[20:23], v[192:195], v[56:59], v[20:23]
    v_mfma_f32_16x16x32_bf16 v[40:43], v[192:195], v[60:63], v[40:43]
    v_mfma_f32_16x16x32_bf16 v[24:27], v[196:199], v[56:59], v[24:27]
    v_mfma_f32_16x16x32_bf16 v[44:47], v[196:199], v[60:63], v[44:47]
    s_waitcnt lgkmcnt(0)
    s_barrier
    v_mfma_f32_16x16x32_bf16 v[8:11], v[200:203], v[64:67], v[8:11]
    ds_read_b64 v[48:49], v240 offset:0
    ds_read_b64 v[50:51], v240 offset:1024
    v_mfma_f32_16x16x32_bf16 v[28:31], v[200:203], v[68:71], v[28:31]
    ds_read_b64 v[52:53], v240 offset:8
    v_mfma_f32_16x16x32_bf16 v[12:15], v[204:207], v[64:67], v[12:15]
    ds_read_b64 v[54:55], v240 offset:1032
    ds_read_b64 v[56:57], v240 offset:2048
    v_mfma_f32_16x16x32_bf16 v[32:35], v[204:207], v[68:71], v[32:35]
    ds_read_b64 v[58:59], v240 offset:3072
    v_mfma_f32_16x16x32_bf16 v[16:19], v[208:211], v[64:67], v[16:19]
    ds_read_b64 v[60:61], v240 offset:2056
    ds_read_b64 v[62:63], v240 offset:3080
    v_mfma_f32_16x16x32_bf16 v[36:39], v[208:211], v[68:71], v[36:39]
    ds_read_b128 v[80:83], v241 offset:36864
    v_mfma_f32_16x16x32_bf16 v[20:23], v[212:215], v[64:67], v[20:23]
    ds_read_b128 v[84:87], v241 offset:37888
    ds_read_b128 v[88:91], v241 offset:38912
    v_mfma_f32_16x16x32_bf16 v[40:43], v[212:215], v[68:71], v[40:43]
    ds_read_b128 v[92:95], v241 offset:39936
    v_mfma_f32_16x16x32_bf16 v[24:27], v[216:219], v[64:67], v[24:27]
    ds_read_b128 v[96:99], v243 offset:40960
    ds_read_b128 v[100:103], v241 offset:41472
    v_mfma_f32_16x16x32_bf16 v[44:47], v[216:219], v[68:71], v[44:47]
    ds_read_b128 v[104:107], v241 offset:42496
    v_mfma_f32_16x16x32_bf16 v[8:11], v[220:223], v[72:75], v[8:11]
    ds_read_b128 v[108:111], v241 offset:43520
    ds_read_b128 v[112:115], v241 offset:44544
    v_mfma_f32_16x16x32_bf16 v[28:31], v[220:223], v[76:79], v[28:31]
    ds_read_b128 v[116:119], v243 offset:45568
    v_mfma_f32_16x16x32_bf16 v[12:15], v[224:227], v[72:75], v[12:15]
    v_mfma_f32_16x16x32_bf16 v[32:35], v[224:227], v[76:79], v[32:35]
    v_mfma_f32_16x16x32_bf16 v[16:19], v[228:231], v[72:75], v[16:19]
    v_mfma_f32_16x16x32_bf16 v[36:39], v[228:231], v[76:79], v[36:39]
    v_mfma_f32_16x16x32_bf16 v[20:23], v[232:235], v[72:75], v[20:23]
    v_mfma_f32_16x16x32_bf16 v[40:43], v[232:235], v[76:79], v[40:43]
    v_mfma_f32_16x16x32_bf16 v[24:27], v[236:239], v[72:75], v[24:27]
    v_mfma_f32_16x16x32_bf16 v[44:47], v[236:239], v[76:79], v[44:47]
    s_waitcnt lgkmcnt(0)
    s_barrier
    v_mfma_f32_16x16x32_bf16 v[8:11], v[80:83], v[48:51], v[8:11]
    ds_read_b64 v[64:65], v240 offset:16384
    ds_read_b64 v[66:67], v240 offset:17408
    v_mfma_f32_16x16x32_bf16 v[28:31], v[80:83], v[52:55], v[28:31]
    ds_read_b64 v[68:69], v240 offset:16392
    v_mfma_f32_16x16x32_bf16 v[12:15], v[84:87], v[48:51], v[12:15]
    ds_read_b64 v[70:71], v240 offset:17416
    ds_read_b64 v[72:73], v240 offset:18432
    v_mfma_f32_16x16x32_bf16 v[32:35], v[84:87], v[52:55], v[32:35]
    ds_read_b64 v[74:75], v240 offset:19456
    v_mfma_f32_16x16x32_bf16 v[16:19], v[88:91], v[48:51], v[16:19]
    ds_read_b64 v[76:77], v240 offset:18440
    ds_read_b64 v[78:79], v240 offset:19464
    v_mfma_f32_16x16x32_bf16 v[36:39], v[88:91], v[52:55], v[36:39]
    ds_read_b128 v[120:123], v242 offset:0
    v_mfma_f32_16x16x32_bf16 v[20:23], v[92:95], v[48:51], v[20:23]
    ds_read_b128 v[124:127], v242 offset:1024
    ds_read_b128 v[128:131], v242 offset:2048
    v_mfma_f32_16x16x32_bf16 v[40:43], v[92:95], v[52:55], v[40:43]
    ds_read_b128 v[132:135], v242 offset:3072
    v_mfma_f32_16x16x32_bf16 v[24:27], v[96:99], v[48:51], v[24:27]
    ds_read_b128 v[136:139], v244 offset:4096
    ds_read_b128 v[140:143], v242 offset:4608
    v_mfma_f32_16x16x32_bf16 v[44:47], v[96:99], v[52:55], v[44:47]
    ds_read_b128 v[144:147], v242 offset:5632
    v_mfma_f32_16x16x32_bf16 v[8:11], v[100:103], v[56:59], v[8:11]
    ds_read_b128 v[148:151], v242 offset:6656
    ds_read_b128 v[152:155], v242 offset:7680
    v_mfma_f32_16x16x32_bf16 v[28:31], v[100:103], v[60:63], v[28:31]
    ds_read_b128 v[156:159], v244 offset:8704
    v_mfma_f32_16x16x32_bf16 v[12:15], v[104:107], v[56:59], v[12:15]
    v_mfma_f32_16x16x32_bf16 v[32:35], v[104:107], v[60:63], v[32:35]
    v_mfma_f32_16x16x32_bf16 v[16:19], v[108:111], v[56:59], v[16:19]
    v_mfma_f32_16x16x32_bf16 v[36:39], v[108:111], v[60:63], v[36:39]
    v_mfma_f32_16x16x32_bf16 v[20:23], v[112:115], v[56:59], v[20:23]
    v_mfma_f32_16x16x32_bf16 v[40:43], v[112:115], v[60:63], v[40:43]
    v_mfma_f32_16x16x32_bf16 v[24:27], v[116:119], v[56:59], v[24:27]
    v_mfma_f32_16x16x32_bf16 v[44:47], v[116:119], v[60:63], v[44:47]
    s_waitcnt lgkmcnt(0)
    s_cmp_ge_u32 s56, 2
    s_cbranch_scc1 L_fin_hi
    v_mfma_f32_16x16x32_bf16 v[28:31], v[120:123], v[68:71], v[28:31]
    v_mfma_f32_16x16x32_bf16 v[32:35], v[124:127], v[68:71], v[32:35]
    v_mfma_f32_16x16x32_bf16 v[36:39], v[128:131], v[68:71], v[36:39]
    v_mfma_f32_16x16x32_bf16 v[40:43], v[132:135], v[68:71], v[40:43]
    v_mfma_f32_16x16x32_bf16 v[44:47], v[136:139], v[68:71], v[44:47]
    v_mfma_f32_16x16x32_bf16 v[28:31], v[140:143], v[76:79], v[28:31]
    v_mfma_f32_16x16x32_bf16 v[32:35], v[144:147], v[76:79], v[32:35]
    v_mfma_f32_16x16x32_bf16 v[36:39], v[148:151], v[76:79], v[36:39]
    v_mfma_f32_16x16x32_bf16 v[40:43], v[152:155], v[76:79], v[40:43]
    v_mfma_f32_16x16x32_bf16 v[44:47], v[156:159], v[76:79], v[44:47]
    v_mfma_f32_16x16x32_bf16 v[8:11], v[120:123], v[64:67], v[8:11]
    v_mfma_f32_16x16x32_bf16 v[12:15], v[124:127], v[64:67], v[12:15]
    v_mfma_f32_16x16x32_bf16 v[16:19], v[128:131], v[64:67], v[16:19]
    v_mfma_f32_16x16x32_bf16 v[20:23], v[132:135], v[64:67], v[20:23]
    v_mfma_f32_16x16x32_bf16 v[24:27], v[136:139], v[64:67], v[24:27]
    ds_write_b128 v246, v[28:31] offset:0
    v_mfma_f32_16x16x32_bf16 v[8:11], v[140:143], v[72:75], v[8:11]
    ds_write_b128 v246, v[32:35] offset:1024
    v_mfma_f32_16x16x32_bf16 v[12:15], v[144:147], v[72:75], v[12:15]
    ds_write_b128 v246, v[36:39] offset:2048
    v_mfma_f32_16x16x32_bf16 v[16:19], v[148:151], v[72:75], v[16:19]
    ds_write_b128 v246, v[40:43] offset:3072
    v_mfma_f32_16x16x32_bf16 v[20:23], v[152:155], v[72:75], v[20:23]
    ds_write_b128 v246, v[44:47] offset:4096
    v_mfma_f32_16x16x32_bf16 v[24:27], v[156:159], v[72:75], v[24:27]
    s_waitcnt lgkmcnt(0)
    s_barrier
    ds_read_b128 v[80:83], v247 offset:0
    ds_read_b128 v[84:87], v247 offset:1024
    ds_read_b128 v[88:91], v247 offset:2048
    ds_read_b128 v[92:95], v247 offset:3072
    ds_read_b128 v[96:99], v247 offset:4096
    s_waitcnt lgkmcnt(4)
    v_pk_add_f32 v[8:9], v[8:9], v[80:81]
    v_pk_add_f32 v[10:11], v[10:11], v[82:83]
    v_cvt_pk_bf16_f32 v104, v8, v9
    v_cvt_pk_bf16_f32 v105, v10, v11
    s_waitcnt lgkmcnt(3)
    v_pk_add_f32 v[12:13], v[12:13], v[84:85]
    v_pk_add_f32 v[14:15], v[14:15], v[86:87]
    v_cvt_pk_bf16_f32 v106, v12, v13
    v_cvt_pk_bf16_f32 v107, v14, v15
    buffer_store_dwordx4 v[104:107], v250, s[36:39], s68 offen
    s_waitcnt lgkmcnt(2)
    v_pk_add_f32 v[16:17], v[16:17], v[88:89]
    v_pk_add_f32 v[18:19], v[18:19], v[90:91]
    v_cvt_pk_bf16_f32 v108, v16, v17
    v_cvt_pk_bf16_f32 v109, v18, v19
    s_waitcnt lgkmcnt(1)
    v_pk_add_f32 v[20:21], v[20:21], v[92:93]
    v_pk_add_f32 v[22:23], v[22:23], v[94:95]
    v_cvt_pk_bf16_f32 v110, v20, v21
    v_cvt_pk_bf16_f32 v111, v22, v23
    buffer_store_dwordx4 v[108:111], v250, s[36:39], s68 offen offset:64
    s_waitcnt lgkmcnt(0)
    v_pk_add_f32 v[24:25], v[24:25], v[96:97]
    v_pk_add_f32 v[26:27], v[26:27], v[98:99]
    v_cvt_pk_bf16_f32 v112, v24, v25
    v_cvt_pk_bf16_f32 v113, v26, v27
    s_branch L_fin_j
L_fin_hi:
    v_mfma_f32_16x16x32_bf16 v[8:11], v[120:123], v[64:67], v[8:11]
    v_mfma_f32_16x16x32_bf16 v[12:15], v[124:127], v[64:67], v[12:15]
    v_mfma_f32_16x16x32_bf16 v[16:19], v[128:131], v[64:67], v[16:19]
    v_mfma_f32_16x16x32_bf16 v[20:23], v[132:135], v[64:67], v[20:23]
    v_mfma_f32_16x16x32_bf16 v[24:27], v[136:139], v[64:67], v[24:27]
    v_mfma_f32_16x16x32_bf16 v[8:11], v[140:143], v[72:75], v[8:11]
    v_mfma_f32_16x16x32_bf16 v[12:15], v[144:147], v[72:75], v[12:15]
    v_mfma_f32_16x16x32_bf16 v[16:19], v[148:151], v[72:75], v[16:19]
    v_mfma_f32_16x16x32_bf16 v[20:23], v[152:155], v[72:75], v[20:23]
    v_mfma_f32_16x16x32_bf16 v[24:27], v[156:159], v[72:75], v[24:27]
    v_mfma_f32_16x16x32_bf16 v[28:31], v[120:123], v[68:71], v[28:31]
    v_mfma_f32_16x16x32_bf16 v[32:35], v[124:127], v[68:71], v[32:35]
    v_mfma_f32_16x16x32_bf16 v[36:39], v[128:131], v[68:71], v[36:39]
    v_mfma_f32_16x16x32_bf16 v[40:43], v[132:135], v[68:71], v[40:43]
    v_mfma_f32_16x16x32_bf16 v[44:47], v[136:139], v[68:71], v[44:47]
    ds_write_b128 v246, v[8:11] offset:0
    v_mfma_f32_16x16x32_bf16 v[28:31], v[140:143], v[76:79], v[28:31]
    ds_write_b128 v246, v[12:15] offset:1024
    v_mfma_f32_16x16x32_bf16 v[32:35], v[144:147], v[76:79], v[32:35]
    ds_write_b128 v246, v[16:19] offset:2048
    v_mfma_f32_16x16x32_bf16 v[36:39], v[148:151], v[76:79], v[36:39]
    ds_write_b128 v246, v[20:23] offset:3072
    v_mfma_f32_16x16x32_bf16 v[40:43], v[152:155], v[76:79], v[40:43]
    ds_write_b128 v246, v[24:27] offset:4096
    v_mfma_f32_16x16x32_bf16 v[44:47], v[156:159], v[76:79], v[44:47]
    s_waitcnt lgkmcnt(0)
    s_barrier
    ds_read_b128 v[80:83], v247 offset:0
    ds_read_b128 v[84:87], v247 offset:1024
    ds_read_b128 v[88:91], v247 offset:2048
    ds_read_b128 v[92:95], v247 offset:3072
    ds_read_b128 v[96:99], v247 offset:4096
    s_waitcnt lgkmcnt(4)
    v_pk_add_f32 v[28:29], v[28:29], v[80:81]
    v_pk_add_f32 v[30:31], v[30:31], v[82:83]
    v_cvt_pk_bf16_f32 v104, v28, v29
    v_cvt_pk_bf16_f32 v105, v30, v31
    s_waitcnt lgkmcnt(3)
    v_pk_add_f32 v[32:33], v[32:33], v[84:85]
    v_pk_add_f32 v[34:35], v[34:35], v[86:87]
    v_cvt_pk_bf16_f32 v106, v32, v33
    v_cvt_pk_bf16_f32 v107, v34, v35
    buffer_store_dwordx4 v[104:107], v250, s[36:39], s68 offen
    s_waitcnt lgkmcnt(2)
    v_pk_add_f32 v[36:37], v[36:37], v[88:89]
    v_pk_add_f32 v[38:39], v[38:39], v[90:91]
    v_cvt_pk_bf16_f32 v108, v36, v37
    v_cvt_pk_bf16_f32 v109, v38, v39
    s_waitcnt lgkmcnt(1)
    v_pk_add_f32 v[40:41], v[40:41], v[92:93]
    v_pk_add_f32 v[42:43], v[42:43], v[94:95]
    v_cvt_pk_bf16_f32 v110, v40, v41
    v_cvt_pk_bf16_f32 v111, v42, v43
    buffer_store_dwordx4 v[108:111], v250, s[36:39], s68 offen offset:64
    s_waitcnt lgkmcnt(0)
    v_pk_add_f32 v[44:45], v[44:45], v[96:97]
    v_pk_add_f32 v[46:47], v[46:47], v[98:99]
    v_cvt_pk_bf16_f32 v112, v44, v45
    v_cvt_pk_bf16_f32 v113, v46, v47
L_fin_j:
    s_mov_b32 exec_hi, 0
    buffer_store_dwordx2 v[112:113], v251, s[36:39], s68 offen offset:128
    s_mov_b32 exec_hi, -1
L_end:
    s_endpgm
.section .rodata,"a"
.p2align 6
.amdhsa_kernel standalone__mixer_gmlp__prompt_kernel
  .amdhsa_next_free_vgpr 256
  .amdhsa_next_free_sgpr 96
  .amdhsa_accum_offset 256
  .amdhsa_group_segment_fixed_size 0
  .amdhsa_kernarg_size 64
  .amdhsa_user_sgpr_count 2
  .amdhsa_user_sgpr_kernarg_segment_ptr 1
  .amdhsa_system_sgpr_workgroup_id_x 1
.end_amdhsa_kernel
```
